```python
import torch

def _softmax(x, axis=-1):
    return torch.softmax(x, dim=axis)
def _gelu(x):
    return torch.nn.functional.gelu(x, approximate="tanh")
def _silu(x):
    return torch.nn.functional.silu(x)
def _sigmoid(x):
    return torch.sigmoid(x)
def _layernorm(x, axis=-1, eps=1e-5):
    m = x.mean(dim=axis, keepdim=True)
    v = x.var(dim=axis, keepdim=True, unbiased=False)
    return (x - m) / torch.sqrt(v + eps)
def _scatter_add(tgt, idx, src, axis=0):
    return tgt.clone().index_add_(axis, idx, src)
def _segment_sum(src, seg, n):
    out = torch.zeros((n,) + src.shape[1:], dtype=src.dtype)
    return out.index_add_(0, seg, src)
def _pad(x, pw):
    flat = tuple(v for pair in reversed(pw) for v in pair)
    return torch.nn.functional.pad(x, flat)

kernel_name = 'recurrent_scan__sliding_block_cached__glu_gated_reglu__decode'

def setup_inputs():

    _w = (lambda a: (lambda t: t.to(torch.bfloat16) if t.is_floating_point() else t)(torch.as_tensor(a)))
    def _A_setup():
        B, Sq, D = 1, 1, 640
        Hq, Hkv, Sk, Dh = 32, 32, 8192, 192
        assert Hq % Hkv == 0, (Hq, Hkv)
        return {
            "x": _w((lambda *s: torch.randn(*s, dtype=torch.bfloat16) * 0.05)(B, Sq, D)),
            "k_cache": _w((lambda *s: torch.randn(*s, dtype=torch.bfloat16) * 3.2)(B, Hkv, Sk, Dh)),
            "v_cache": _w((lambda *s: torch.randn(*s, dtype=torch.bfloat16) * 3.2)(B, Hkv, Sk, Dh)),
            "wq": _w((lambda *s: torch.randn(*s, dtype=torch.bfloat16) * 3.2)(D, Hq * Dh) * (D ** -0.5)),
            "wo": _w((lambda *s: torch.randn(*s, dtype=torch.bfloat16) * 3.2)(Hq * Dh, D) * ((Hq * Dh) ** -0.5)),
        }
    _A_in = _A_setup()

    def _B_setup():
        B, S, D, F = 1, 1, 640, 1536
        return {
            "x": _w((lambda *s: torch.randn(*s, dtype=torch.bfloat16) * 0.05)(B, S, D)),
            "W_gate": _w((lambda *s: torch.randn(*s, dtype=torch.bfloat16) * 0.4)(D, F) * (2.0 / D) ** 0.5),
            "W_up": _w((lambda *s: torch.randn(*s, dtype=torch.bfloat16) * 0.4)(D, F) * (2.0 / D) ** 0.5),
            "W_down": _w((lambda *s: torch.randn(*s, dtype=torch.bfloat16) * 0.4)(F, D) * (1.0 / F) ** 0.5),
        }
    _B_in = _B_setup()

    return {
        "A_x": _A_in["x"],
        "A_k_cache": _A_in["k_cache"],
        "A_v_cache": _A_in["v_cache"],
        "A_wq": _A_in["wq"],
        "A_wo": _A_in["wo"],
        "B_x": _B_in["x"],
        "B_W_gate": _B_in["W_gate"],
        "B_W_up": _B_in["W_up"],
        "B_W_down": _B_in["W_down"],
    }

def reference(A_x, A_k_cache, A_v_cache, A_wq, A_wo, B_x, B_W_gate, B_W_up, B_W_down):
    def _A_ref(x, k_cache, v_cache, wq, wo):
        B, Sq, D = x.shape
        Hq, Dh = 32, 192
        Hkv, Sk = k_cache.shape[1], k_cache.shape[2]
        W = min(4096, max(256, Sk // 4))
        rep = Hq // Hkv
        q = (lambda x, *d: x.permute(*d))((x @ wq).reshape(B, Sq, Hq, Dh), 0, 2, 1, 3)
        k = (lambda x, n, axis: torch.repeat_interleave(x, n, dim=axis))(k_cache[:, :, Sk - W:, :], rep, axis=1)
        v = (lambda x, n, axis: torch.repeat_interleave(x, n, dim=axis))(v_cache[:, :, Sk - W:, :], rep, axis=1)
        scores = torch.einsum("bhqd,bhkd->bhqk", q, k) * (Dh ** -0.5)
        p = _softmax(scores, axis=-1)
        o = torch.einsum("bhqk,bhkd->bhqd", p, v)
        return (lambda x, *d: x.permute(*d))(o, 0, 2, 1, 3).reshape(B, Sq, Hq * Dh) @ wo

    def _B_ref(x, W_gate, W_up, W_down):
        gate = torch.einsum("bsd,df->bsf", x, W_gate)
        up = torch.einsum("bsd,df->bsf", x, W_up)
        gate = gate * (lambda x, dt: x.to(dt))(gate > 0, gate.dtype)
        h = gate * up
        return torch.einsum("bsf,fd->bsd", h, W_down)

    x = A_x
    xn = _layernorm(x, axis=-1)
    s = _A_ref(xn, A_k_cache, A_v_cache, A_wq, A_wo)
    g = _silu(_B_ref(xn, B_W_gate, B_W_up, B_W_down))
    return x + s * g
```

```asm
; @launch grid=(256,1,1) block=(512,1,1) lds=29312
.amdgcn_target "amdgcn-amd-amdhsa--gfx950"
.text
.globl recurrent_scan__sliding_block_cached__glu_gated_reglu__decode_kernel
.p2align 8
.type recurrent_scan__sliding_block_cached__glu_gated_reglu__decode_kernel,@function
recurrent_scan__sliding_block_cached__glu_gated_reglu__decode_kernel:
    s_cmp_ge_u32 s2, 256
    s_cbranch_scc1 L_end
    s_load_dwordx16 s[4:19], s[0:1], 0
    s_load_dwordx8 s[20:27], s[0:1], 64
    v_lshrrev_b32 v3, 6, v0
    v_and_b32 v0, 63, v0
    v_readfirstlane_b32 s3, v3
    v_lshrrev_b32 v1, 3, v0
    v_and_b32 v27, 7, v0
    v_lshlrev_b32 v2, 4, v27
    s_and_b32 s60, s2, 31
    s_lshr_b32 s61, s2, 5
    v_mov_b32 v26, 0
    v_mov_b32 v200, 0
    v_mov_b32 v201, 0
    v_mov_b32 v202, 0
    v_mov_b32 v203, 0
    ds_write_b128 v26, v[200:203]
    ds_write_b128 v26, v[200:203] offset:16
    s_cmp_ge_u32 s3, 4
    s_cbranch_scc0 L_pr_1
    s_setprio 1
L_pr_1:
    s_cmp_lt_u32 s3, 5
    s_cbranch_scc0 L_roleB
    s_cmp_lt_u32 s3, 3
    s_movk_i32 s77, 0xc00
    s_cselect_b32 s76, 0x3000, s77
    v_mul_u32_u24 v9, s76, v1
    v_add_u32 v9, v9, v2
    s_lshl_b32 s70, s76, 3
    s_mul_i32 s77, s61, 80
    s_mul_i32 s77, s77, s76
    s_mul_i32 s78, s60, 384
    s_lshl_b32 s79, s3, 7
    s_add_u32 s78, s78, s79
    s_lshl_b32 s79, s60, 7
    s_cmp_lt_u32 s60, 24
    s_cselect_b32 s79, s79, 0x7f000000
    s_cmp_lt_u32 s3, 3
    s_cselect_b32 s78, s78, s79
    s_add_u32 s69, s77, s78
    s_waitcnt lgkmcnt(0)
    s_cmp_eq_u32 s3, 3
    s_cselect_b32 s76, s16, s10
    s_cselect_b32 s77, s17, s11
    s_cmp_eq_u32 s3, 4
    s_cselect_b32 s36, s18, s76
    s_cselect_b32 s37, s19, s77
    s_and_b32 s37, s37, 0xffff
    s_mov_b32 s76, 1966080
    s_cmp_lt_u32 s3, 3
    s_cselect_b32 s38, 7864320, s76
    s_mov_b32 s39, 0x20000
    buffer_load_dwordx4 v[128:131], v9, s[36:39], s69 offen nt
    s_add_u32 s69, s69, s70
    buffer_load_dwordx4 v[132:135], v9, s[36:39], s69 offen nt
    s_add_u32 s69, s69, s70
    buffer_load_dwordx4 v[136:139], v9, s[36:39], s69 offen nt
    s_add_u32 s69, s69, s70
    buffer_load_dwordx4 v[140:143], v9, s[36:39], s69 offen nt
    s_add_u32 s69, s69, s70
    buffer_load_dwordx4 v[144:147], v9, s[36:39], s69 offen nt
    s_add_u32 s69, s69, s70
    buffer_load_dwordx4 v[148:151], v9, s[36:39], s69 offen nt
    s_add_u32 s69, s69, s70
    buffer_load_dwordx4 v[152:155], v9, s[36:39], s69 offen nt
    s_add_u32 s69, s69, s70
    buffer_load_dwordx4 v[156:159], v9, s[36:39], s69 offen nt
    s_add_u32 s69, s69, s70
    buffer_load_dwordx4 v[160:163], v9, s[36:39], s69 offen nt
    s_add_u32 s69, s69, s70
    buffer_load_dwordx4 v[164:167], v9, s[36:39], s69 offen nt
    s_barrier
    s_load_dword s73, s[26:27], 0
    s_mov_b32 s28, s6
    s_and_b32 s29, s7, 0xffff
    s_mov_b32 s30, 100663296
    s_mov_b32 s31, 0x20000
    s_mov_b32 s32, s8
    s_and_b32 s33, s9, 0xffff
    s_mov_b32 s34, 100663296
    s_mov_b32 s35, 0x20000
    s_mov_b32 s48, s26
    s_and_b32 s49, s27, 0xffff
    s_mov_b32 s50, 4194304
    s_mov_b32 s51, 0x20000
    s_mov_b32 s40, s12
    s_and_b32 s41, s13, 0xffff
    s_mov_b32 s42, 7864320
    s_mov_b32 s43, 0x20000
    s_mov_b32 s44, s20
    s_and_b32 s45, s21, 0xffff
    s_mov_b32 s46, 1966080
    s_mov_b32 s47, 0x20000
    s_mul_i32 s65, s60, 3145728
    s_lshl_b32 s76, s61, 8
    s_lshl_b32 s77, s3, 5
    s_add_u32 s76, s76, s77
    s_add_u32 s76, s76, 6144
    s_mul_i32 s76, s76, 384
    s_add_u32 s65, s65, s76
    s_add_u32 s66, s65, 3072
    s_add_u32 s67, s65, 6144
    s_add_u32 s68, s65, 9216
    v_mul_u32_u24 v8, 384, v1
    v_add_u32 v8, v8, v2
    s_lshl_b32 s62, s60, 3
    s_add_u32 s62, s62, s61
    s_lshr_b32 s63, s61, 1
    s_and_b32 s64, s61, 1
    s_lshl_b32 s93, s60, 10
    s_add_u32 s93, s93, 1576960
    s_getreg_b32 s92, hwreg(HW_REG_XCC_ID, 0, 4)
    v_and_b32 v204, 1, v0
    v_cmp_eq_u32 vcc, 1, v204
    v_mov_b32 v205, 0xffff
    v_mov_b32 v206, 0xffff0000
    v_cndmask_b32 v207, v205, v206, vcc
    v_bfe_u32 v204, v0, 1, 2
    v_cmp_eq_u32 vcc, 0, v204
    s_nop 1
    v_cndmask_b32 v4, 0, v207, vcc
    v_cmp_eq_u32 vcc, 1, v204
    s_nop 1
    v_cndmask_b32 v5, 0, v207, vcc
    v_cmp_eq_u32 vcc, 2, v204
    s_nop 1
    v_cndmask_b32 v6, 0, v207, vcc
    v_cmp_eq_u32 vcc, 3, v204
    s_nop 1
    v_cndmask_b32 v7, 0, v207, vcc
    v_mov_b32 v11, 0x3ff
    v_mov_b32 v12, 0x200
    v_add_u32 v13, 64, v2
    s_lshl_b32 s76, s62, 10
    s_lshl_b32 s77, s3, 7
    s_add_u32 s76, s76, s77
    s_add_u32 s90, s76, 659456
    s_lshl_b32 s76, s60, 13
    s_lshl_b32 s77, s3, 10
    s_add_u32 s76, s76, s77
    s_lshl_b32 s77, s61, 4
    s_add_u32 s76, s76, s77
    s_add_u32 s82, s76, 3866624
    v_and_b32 v204, 7, v0
    v_bfe_u32 v205, v0, 4, 1
    v_lshrrev_b32 v206, 5, v0
    v_mov_b32 v3, 0x80000000
    v_lshlrev_b32 v17, 4, v1
    v_lshlrev_b32 v25, 7, v1
    v_cmp_eq_u32 vcc, 0, v204
    s_nop 1
    v_cndmask_b32 v17, v3, v17, vcc
    v_cndmask_b32 v25, v3, v25, vcc
    v_mul_u32_u24 v10, 0x500, v1
    v_add_u32 v10, v10, v2
    s_mul_i32 s76, s64, 640
    s_lshl_b32 s77, s3, 7
    s_add_u32 s76, s76, s77
    s_mul_i32 s77, s60, 192
    s_mul_i32 s78, s63, 48
    s_add_u32 s77, s77, s78
    s_mul_i32 s77, s77, 1280
    s_add_u32 s71, s77, s76
    s_lshl_b32 s77, s60, 6
    s_lshl_b32 s78, s63, 4
    s_add_u32 s77, s77, s78
    s_mul_i32 s77, s77, 1280
    s_add_u32 s72, s77, s76
    s_mul_i32 s76, s62, 2560
    s_lshl_b32 s77, s3, 9
    s_add_u32 s76, s76, s77
    s_add_u32 s80, s76, 3145728
    s_add_u32 s81, s76, 4096
    s_lshl_b32 s76, s60, 13
    s_lshl_b32 s77, s63, 8
    s_add_u32 s83, s76, s77
    s_mul_i32 s76, s62, 1280
    s_lshl_b32 s77, s3, 8
    s_add_u32 s76, s76, s77
    s_add_u32 s84, s76, 921600
    s_add_u32 s85, s76, 1249280
    v_lshl_add_u32 v207, v204, 1, v205
    v_lshlrev_b32 v14, 5, v207
    v_lshl_add_u32 v14, v206, 4, v14
    v_lshlrev_b32 v16, 4, v207
    v_lshl_add_u32 v16, v206, 3, v16
    v_and_b32 v208, 8, v0
    v_cmp_eq_u32 vcc, 0, v208
    s_nop 1
    v_cndmask_b32 v14, v3, v14, vcc
    v_cndmask_b32 v16, v3, v16, vcc
    v_cmp_gt_u32 vcc, 32, v0
    s_nop 1
    v_cndmask_b32 v16, v3, v16, vcc
    v_lshlrev_b32 v18, 10, v204
    v_lshl_add_u32 v18, v1, 5, v18
    s_lshl_b32 s76, s3, 1
    v_add_u32 v208, s76, v206
    v_mul_u32_u24 v208, 420, v208
    v_add_u32 v23, 6, v208
    v_mul_u32_u24 v3, 48, v205
    v_add_u32 v208, v208, v3
    v_add_u32 v19, 0, v204
    v_mul_u32_u24 v3, 43, v19
    v_lshrrev_b32 v3, 8, v3
    v_mul_u32_u24 v3, 98, v3
    v_add3_u32 v19, v19, v3, v208
    v_lshlrev_b32 v19, 2, v19
    v_add_u32 v19, 2432, v19
    v_add_u32 v20, 8, v204
    v_mul_u32_u24 v3, 43, v20
    v_lshrrev_b32 v3, 8, v3
    v_mul_u32_u24 v3, 98, v3
    v_add3_u32 v20, v20, v3, v208
    v_lshlrev_b32 v20, 2, v20
    v_add_u32 v20, 2432, v20
    v_add_u32 v21, 16, v204
    v_mul_u32_u24 v3, 43, v21
    v_lshrrev_b32 v3, 8, v3
    v_mul_u32_u24 v3, 98, v3
    v_add3_u32 v21, v21, v3, v208
    v_lshlrev_b32 v21, 2, v21
    v_add_u32 v21, 2432, v21
    v_mul_u32_u24 v22, 840, v204
    s_lshr_b32 s76, s3, 1
    s_mul_i32 s76, s76, 104
    s_and_b32 s77, s3, 1
    s_mul_i32 s77, s77, 48
    s_add_u32 s76, s76, s77
    v_lshrrev_b32 v3, 4, v0
    v_mul_u32_u24 v3, 12, v3
    v_add3_u32 v22, v22, v3, s76
    v_bfe_u32 v3, v0, 3, 1
    v_lshl_add_u32 v22, v3, 2, v22
    v_lshlrev_b32 v22, 2, v22
    v_add_u32 v22, 2432, v22
    s_mov_b32 s88, 0xff00ff00
    s_mov_b32 s89, 0xff00ff00
    v_lshlrev_b32 v255, 2, v204
    v_add_u32 v255, 32, v255
    v_bfe_u32 v3, v0, 3, 2
    v_mul_u32_u24 v3, 104, v3
    v_add_u32 v23, v23, v3
    v_mul_u32_u24 v3, 12, v204
    v_add_u32 v23, v23, v3
    v_lshlrev_b32 v23, 2, v23
    v_add_u32 v23, 2432, v23
    v_lshlrev_b32 v29, 2, v1
    v_add_u32 v29, 2048, v29
    s_mov_b32 s86, 0
L_lw_2:
    ds_read_b32 v27, v26 offset:20
    s_add_u32 s86, s86, 1
    s_waitcnt lgkmcnt(0)
    v_cmp_ne_u32 vcc, 1, v27
    s_cmp_gt_u32 s86, 1048576
    s_cbranch_scc1 L_le_3
    s_cbranch_vccnz L_lw_2
L_le_3:
    ds_read_b32 v224, v29 offset:0
    ds_read_b32 v225, v29 offset:32
    ds_read_b32 v226, v29 offset:64
    ds_read_b32 v227, v29 offset:96
    ds_read_b32 v228, v29 offset:128
    ds_read_b32 v229, v29 offset:160
    ds_read_b32 v230, v29 offset:192
    ds_read_b32 v231, v29 offset:224
    ds_read_b32 v232, v29 offset:256
    ds_read_b32 v233, v29 offset:288
    s_waitcnt lgkmcnt(0)
    s_add_u32 s73, s73, 1
    s_and_b32 s74, s73, 0x3ff
    s_lshr_b32 s76, s73, 10
    s_add_u32 s76, s76, s73
    s_and_b32 s75, s76, 0x3ff
    v_and_b32 v240, v224, v4
    v_and_b32 v241, v224, v5
    v_and_b32 v242, v224, v6
    v_and_b32 v243, v224, v7
    s_waitcnt vmcnt(9)
    s_nop 0
    v_mfma_f32_16x16x32_bf16 v[212:215], v[240:243], v[128:131], 0
    v_and_b32 v244, v225, v4
    v_and_b32 v245, v225, v5
    v_and_b32 v246, v225, v6
    v_and_b32 v247, v225, v7
    s_waitcnt vmcnt(8)
    s_nop 0
    v_mfma_f32_16x16x32_bf16 v[212:215], v[244:247], v[132:135], v[212:215]
    v_and_b32 v240, v226, v4
    v_and_b32 v241, v226, v5
    v_and_b32 v242, v226, v6
    v_and_b32 v243, v226, v7
    s_waitcnt vmcnt(7)
    s_nop 0
    v_mfma_f32_16x16x32_bf16 v[212:215], v[240:243], v[136:139], v[212:215]
    v_and_b32 v244, v227, v4
    v_and_b32 v245, v227, v5
    v_and_b32 v246, v227, v6
    v_and_b32 v247, v227, v7
    s_waitcnt vmcnt(6)
    s_nop 0
    v_mfma_f32_16x16x32_bf16 v[212:215], v[244:247], v[140:143], v[212:215]
    v_and_b32 v240, v228, v4
    v_and_b32 v241, v228, v5
    v_and_b32 v242, v228, v6
    v_and_b32 v243, v228, v7
    s_waitcnt vmcnt(5)
    s_nop 0
    v_mfma_f32_16x16x32_bf16 v[212:215], v[240:243], v[144:147], v[212:215]
    v_and_b32 v244, v229, v4
    v_and_b32 v245, v229, v5
    v_and_b32 v246, v229, v6
    v_and_b32 v247, v229, v7
    s_waitcnt vmcnt(4)
    s_nop 0
    v_mfma_f32_16x16x32_bf16 v[212:215], v[244:247], v[148:151], v[212:215]
    buffer_load_dwordx4 v[32:35], v8, s[28:31], s65 offen offset:0 nt
    v_and_b32 v240, v230, v4
    v_and_b32 v241, v230, v5
    v_and_b32 v242, v230, v6
    v_and_b32 v243, v230, v7
    s_waitcnt vmcnt(4)
    s_nop 0
    v_mfma_f32_16x16x32_bf16 v[212:215], v[240:243], v[152:155], v[212:215]
    buffer_load_dwordx4 v[36:39], v8, s[28:31], s65 offen offset:128 nt
    v_and_b32 v244, v231, v4
    v_and_b32 v245, v231, v5
    v_and_b32 v246, v231, v6
    v_and_b32 v247, v231, v7
    s_waitcnt vmcnt(4)
    s_nop 0
    v_mfma_f32_16x16x32_bf16 v[212:215], v[244:247], v[156:159], v[212:215]
    buffer_load_dwordx4 v[40:43], v8, s[28:31], s65 offen offset:256 nt
    v_and_b32 v240, v232, v4
    v_and_b32 v241, v232, v5
    v_and_b32 v242, v232, v6
    v_and_b32 v243, v232, v7
    s_waitcnt vmcnt(4)
    s_nop 0
    v_mfma_f32_16x16x32_bf16 v[212:215], v[240:243], v[160:163], v[212:215]
    buffer_load_dwordx4 v[44:47], v8, s[28:31], s66 offen offset:0 nt
    v_and_b32 v244, v233, v4
    v_and_b32 v245, v233, v5
    v_and_b32 v246, v233, v6
    v_and_b32 v247, v233, v7
    s_waitcnt vmcnt(4)
    s_nop 0
    v_mfma_f32_16x16x32_bf16 v[212:215], v[244:247], v[164:167], v[212:215]
    buffer_load_dwordx4 v[48:51], v8, s[28:31], s66 offen offset:128 nt
    v_mov_b32 v165, s73
    v_mov_b32 v167, s73
    s_nop 4
    v_permlane32_swap_b32 v212, v214
    v_permlane32_swap_b32 v213, v215
    s_nop 0
    v_add_f32_dpp v164, v214, v212 row_ror:8 row_mask:0xf bank_mask:0xf
    v_add_f32_dpp v166, v215, v213 row_ror:8 row_mask:0xf bank_mask:0xf
    buffer_store_dwordx4 v[164:167], v14, s[48:51], s80 offen
    s_waitcnt vmcnt(4)
    buffer_load_dwordx4 v[52:55], v8, s[28:31], s66 offen offset:256 nt
    s_waitcnt vmcnt(4)
    buffer_load_dwordx4 v[56:59], v8, s[28:31], s67 offen offset:0 nt
    s_waitcnt vmcnt(4)
    buffer_load_dwordx4 v[60:63], v8, s[28:31], s67 offen offset:128 nt
    v_and_b32 v31, 7, v0
    v_lshlrev_b32 v31, 7, v31
    buffer_load_dwordx2 v[210:211], v31, s[48:51], s93 offen sc1
    s_waitcnt vmcnt(4)
    buffer_load_dwordx4 v[64:67], v8, s[28:31], s67 offen offset:256 nt
    s_waitcnt vmcnt(3)
    buffer_load_dwordx4 v[68:71], v8, s[28:31], s68 offen offset:0 nt
    s_waitcnt vmcnt(3)
    buffer_load_dwordx4 v[72:75], v8, s[28:31], s68 offen offset:128 nt
    s_waitcnt vmcnt(3)
    buffer_load_dwordx4 v[76:79], v8, s[28:31], s68 offen offset:256 nt
    s_waitcnt vmcnt(3)
    buffer_load_dwordx4 v[80:83], v8, s[32:35], s65 offen offset:0 nt
    s_waitcnt vmcnt(3)
    buffer_load_dwordx4 v[84:87], v8, s[32:35], s65 offen offset:128 nt
    s_waitcnt vmcnt(3)
    buffer_load_dwordx4 v[88:91], v8, s[32:35], s65 offen offset:256 nt
    s_waitcnt vmcnt(3)
    buffer_load_dwordx4 v[92:95], v8, s[32:35], s66 offen offset:0 nt
    s_waitcnt vmcnt(3)
    buffer_load_dwordx4 v[96:99], v8, s[32:35], s66 offen offset:128 nt
    s_waitcnt vmcnt(3)
    buffer_load_dwordx4 v[100:103], v8, s[32:35], s66 offen offset:256 nt
    s_waitcnt vmcnt(3)
    buffer_load_dwordx4 v[104:107], v8, s[32:35], s67 offen offset:0 nt
    s_waitcnt vmcnt(3)
    buffer_load_dwordx4 v[108:111], v8, s[32:35], s67 offen offset:128 nt
    s_waitcnt vmcnt(3)
    buffer_load_dwordx4 v[112:115], v8, s[32:35], s67 offen offset:256 nt
    s_waitcnt vmcnt(3)
    buffer_load_dwordx4 v[116:119], v8, s[32:35], s68 offen offset:0 nt
    s_waitcnt vmcnt(3)
    buffer_load_dwordx4 v[120:123], v8, s[32:35], s68 offen offset:128 nt
    s_waitcnt vmcnt(3)
    buffer_load_dwordx4 v[124:127], v8, s[32:35], s68 offen offset:256 nt
    buffer_load_dwordx4 v[168:171], v10, s[44:47], s72 offen nt
    s_add_u32 s72, s72, 10240
    buffer_load_dwordx4 v[172:175], v10, s[44:47], s72 offen nt
    buffer_load_dwordx4 v[176:179], v10, s[40:43], s71 offen nt
    s_add_u32 s71, s71, 10240
    buffer_load_dwordx4 v[180:183], v10, s[40:43], s71 offen nt
    s_add_u32 s71, s71, 10240
    buffer_load_dwordx4 v[184:187], v10, s[40:43], s71 offen nt
    s_add_u32 s71, s71, 10240
    buffer_load_dwordx4 v[188:191], v10, s[40:43], s71 offen nt
    s_add_u32 s71, s71, 10240
    buffer_load_dwordx4 v[192:195], v10, s[40:43], s71 offen nt
    s_add_u32 s71, s71, 10240
    buffer_load_dwordx4 v[196:199], v10, s[40:43], s71 offen nt
    v_cmp_ne_u32 vcc, s73, v210
    s_nop 0
    s_cbranch_vccz L_ok_4
    s_mov_b32 s86, 0
L_rt_5:
    v_and_b32 v31, 7, v0
    v_lshlrev_b32 v31, 7, v31
    buffer_load_dwordx2 v[210:211], v31, s[48:51], s93 offen sc1
    s_waitcnt vmcnt(0)
    v_cmp_ne_u32 vcc, s73, v210
    s_add_u32 s86, s86, 1
    s_cmp_gt_u32 s86, 65536
    s_cbranch_scc1 L_ok_4
    s_cbranch_vccnz L_rt_5
L_ok_4:
    v_cmp_ne_u32 vcc, s92, v211
    s_nop 0
    s_cmp_lg_u64 vcc, 0
    s_cselect_b32 s91, 1, 0
    s_cmp_lg_u32 s91, 0
    s_cselect_b32 s81, s81, 0x7f000000
    s_cbranch_scc0 L_lc_6
    s_add_u32 s83, s83, 659456
    s_branch L_jn_7
L_lc_6:
    s_lshl_b32 s76, s60, 13
    s_lshl_b32 s77, s63, 11
    s_add_u32 s76, s76, s77
    s_add_u32 s83, s76, 3866624
    v_lshl_add_u32 v18, v1, 8, v2
L_jn_7:
    s_cmp_lg_u32 s91, 0
    s_cselect_b32 s82, 0x7f000000, s82
    s_cselect_b32 s90, s90, 0x7f000000
    buffer_store_dwordx4 v[164:167], v14, s[48:51], s81 offen sc1
    s_mov_b32 s86, 0
L_lw_8:
    ds_read_b128 v[248:251], v26
    ds_read_b32 v252, v26 offset:16
    s_add_u32 s86, s86, 1
    s_waitcnt lgkmcnt(0)
    v_and_b32 v248, v248, v249
    v_and_b32 v250, v250, v251
    v_bitop3_b32 v248, v248, v250, v252 bitop3:0x80
    v_cmp_ne_u32 vcc, 1, v248
    s_cmp_gt_u32 s86, 1048576
    s_cbranch_scc1 L_le_9
    s_cbranch_vccnz L_lw_8
L_le_9:
    ds_read_b128 v[200:203], v13 offset:0
    ds_read_b128 v[204:207], v13 offset:128
    ds_read_b128 v[208:211], v13 offset:256
    s_waitcnt lgkmcnt(0)
    v_dot2_f32_bf16 v240, v32, v200, 0
    v_dot2_f32_bf16 v241, v44, v200, 0
    v_dot2_f32_bf16 v242, v56, v200, 0
    v_dot2_f32_bf16 v243, v68, v200, 0
    v_dot2_f32_bf16 v240, v33, v201, v240
    v_dot2_f32_bf16 v241, v45, v201, v241
    v_dot2_f32_bf16 v242, v57, v201, v242
    v_dot2_f32_bf16 v243, v69, v201, v243
    v_dot2_f32_bf16 v240, v34, v202, v240
    v_dot2_f32_bf16 v241, v46, v202, v241
    v_dot2_f32_bf16 v242, v58, v202, v242
    v_dot2_f32_bf16 v243, v70, v202, v243
    v_dot2_f32_bf16 v240, v35, v203, v240
    v_dot2_f32_bf16 v241, v47, v203, v241
    v_dot2_f32_bf16 v242, v59, v203, v242
    v_dot2_f32_bf16 v243, v71, v203, v243
    v_dot2_f32_bf16 v240, v36, v204, v240
    v_dot2_f32_bf16 v241, v48, v204, v241
    v_dot2_f32_bf16 v242, v60, v204, v242
    v_dot2_f32_bf16 v243, v72, v204, v243
    v_dot2_f32_bf16 v240, v37, v205, v240
    v_dot2_f32_bf16 v241, v49, v205, v241
    v_dot2_f32_bf16 v242, v61, v205, v242
    v_dot2_f32_bf16 v243, v73, v205, v243
    v_dot2_f32_bf16 v240, v38, v206, v240
    v_dot2_f32_bf16 v241, v50, v206, v241
    v_dot2_f32_bf16 v242, v62, v206, v242
    v_dot2_f32_bf16 v243, v74, v206, v243
    v_dot2_f32_bf16 v240, v39, v207, v240
    v_dot2_f32_bf16 v241, v51, v207, v241
    v_dot2_f32_bf16 v242, v63, v207, v242
    v_dot2_f32_bf16 v243, v75, v207, v243
    v_dot2_f32_bf16 v240, v40, v208, v240
    v_dot2_f32_bf16 v241, v52, v208, v241
    v_dot2_f32_bf16 v242, v64, v208, v242
    v_dot2_f32_bf16 v243, v76, v208, v243
    v_dot2_f32_bf16 v240, v41, v209, v240
    v_dot2_f32_bf16 v241, v53, v209, v241
    v_dot2_f32_bf16 v242, v65, v209, v242
    v_dot2_f32_bf16 v243, v77, v209, v243
    v_dot2_f32_bf16 v240, v42, v210, v240
    v_dot2_f32_bf16 v241, v54, v210, v241
    v_dot2_f32_bf16 v242, v66, v210, v242
    v_dot2_f32_bf16 v243, v78, v210, v243
    v_dot2_f32_bf16 v240, v43, v211, v240
    v_dot2_f32_bf16 v241, v55, v211, v241
    v_dot2_f32_bf16 v242, v67, v211, v242
    v_dot2_f32_bf16 v243, v79, v211, v243
    v_add_f32_dpp v240, v240, v240 quad_perm:[1,0,3,2] row_mask:0xf bank_mask:0xf
    v_add_f32_dpp v241, v241, v241 quad_perm:[1,0,3,2] row_mask:0xf bank_mask:0xf
    v_add_f32_dpp v242, v242, v242 quad_perm:[1,0,3,2] row_mask:0xf bank_mask:0xf
    v_add_f32_dpp v243, v243, v243 quad_perm:[1,0,3,2] row_mask:0xf bank_mask:0xf
    v_add_f32_dpp v240, v240, v240 quad_perm:[2,3,0,1] row_mask:0xf bank_mask:0xf
    v_add_f32_dpp v241, v241, v241 quad_perm:[2,3,0,1] row_mask:0xf bank_mask:0xf
    v_add_f32_dpp v242, v242, v242 quad_perm:[2,3,0,1] row_mask:0xf bank_mask:0xf
    v_add_f32_dpp v243, v243, v243 quad_perm:[2,3,0,1] row_mask:0xf bank_mask:0xf
    v_add_f32_dpp v240, v240, v240 row_half_mirror row_mask:0xf bank_mask:0xf
    v_add_f32_dpp v241, v241, v241 row_half_mirror row_mask:0xf bank_mask:0xf
    v_add_f32_dpp v242, v242, v242 row_half_mirror row_mask:0xf bank_mask:0xf
    v_add_f32_dpp v243, v243, v243 row_half_mirror row_mask:0xf bank_mask:0xf
    v_cvt_pk_bf16_f32 v240, v240, v240
    v_cvt_pk_bf16_f32 v241, v241, v241
    v_cvt_pk_bf16_f32 v242, v242, v242
    v_cvt_pk_bf16_f32 v243, v243, v243
    v_and_b32 v240, 0xffff0000, v240
    v_and_b32 v241, 0xffff0000, v241
    v_and_b32 v242, 0xffff0000, v242
    v_and_b32 v243, 0xffff0000, v243
    v_mul_f32 v240, 0x3d93cd3a, v240
    v_mul_f32 v241, 0x3d93cd3a, v241
    v_mul_f32 v242, 0x3d93cd3a, v242
    v_mul_f32 v243, 0x3d93cd3a, v243
    v_cvt_pk_bf16_f32 v240, v240, v240
    v_cvt_pk_bf16_f32 v241, v241, v241
    v_cvt_pk_bf16_f32 v242, v242, v242
    v_cvt_pk_bf16_f32 v243, v243, v243
    v_and_b32 v240, 0xffff0000, v240
    v_and_b32 v241, 0xffff0000, v241
    v_and_b32 v242, 0xffff0000, v242
    v_and_b32 v243, 0xffff0000, v243
    v_max3_f32 v244, v240, v241, v242
    v_max_f32 v244, v244, v243
    s_nop 1
    v_max_f32_dpp v244, v244, v244 row_ror:8 row_mask:0xf bank_mask:0xf
    v_mov_b32 v245, v244
    s_nop 1
    v_permlane16_swap_b32 v245, v244
    v_max_f32 v244, v244, v245
    v_mov_b32 v245, v244
    s_nop 1
    v_permlane32_swap_b32 v245, v244
    v_max_f32 v244, v244, v245
    v_sub_f32 v240, v240, v244
    v_sub_f32 v241, v241, v244
    v_sub_f32 v242, v242, v244
    v_sub_f32 v243, v243, v244
    s_lshl_b32 s76, s3, 2
    s_add_u32 s76, s76, 32
    v_mov_b32 v245, s76
    v_mul_f32 v240, 0x3fb8aa3b, v240
    v_mul_f32 v241, 0x3fb8aa3b, v241
    v_mul_f32 v242, 0x3fb8aa3b, v242
    v_mul_f32 v243, 0x3fb8aa3b, v243
    ds_write_b32 v245, v244
    v_exp_f32 v240, v240
    v_exp_f32 v241, v241
    v_exp_f32 v242, v242
    v_exp_f32 v243, v243
    v_add_f32 v246, v240, v241
    v_add_f32 v247, v242, v243
    v_add_f32 v246, v246, v247
    v_cvt_pk_bf16_f32 v240, v240, v240
    v_cvt_pk_bf16_f32 v241, v241, v241
    v_cvt_pk_bf16_f32 v242, v242, v242
    v_cvt_pk_bf16_f32 v243, v243, v243
    v_add_f32_dpp v246, v246, v246 row_ror:8 row_mask:0xf bank_mask:0xf
    v_and_b32 v224, v240, v4
    v_and_b32 v225, v240, v5
    v_and_b32 v226, v240, v6
    v_and_b32 v227, v240, v7
    v_and_b32 v228, v241, v4
    v_and_b32 v229, v241, v5
    v_and_b32 v230, v241, v6
    v_and_b32 v231, v241, v7
    v_and_b32 v232, v242, v4
    v_and_b32 v233, v242, v5
    v_and_b32 v234, v242, v6
    v_and_b32 v235, v242, v7
    v_and_b32 v236, v243, v4
    v_and_b32 v237, v243, v5
    v_and_b32 v238, v243, v6
    v_and_b32 v239, v243, v7
    v_mov_b32 v247, v246
    s_nop 1
    v_permlane16_swap_b32 v247, v246
    v_add_f32 v246, v246, v247
    v_mov_b32 v247, v246
    s_nop 1
    v_permlane32_swap_b32 v247, v246
    v_add_f32 v246, v246, v247
    v_cmp_gt_u32 vcc, 32, v0
    v_mov_b32 v248, 0
    s_nop 0
    v_cndmask_b32 v249, 0, v246, vcc
    ds_write_b64 v23, v[248:249]
    v_mfma_f32_16x16x32_bf16 v[212:215], v[224:227], v[80:83], 0
    v_mfma_f32_16x16x32_bf16 v[216:219], v[224:227], v[84:87], 0
    v_mfma_f32_16x16x32_bf16 v[220:223], v[224:227], v[88:91], 0
    v_mfma_f32_16x16x32_bf16 v[212:215], v[228:231], v[92:95], v[212:215]
    v_mfma_f32_16x16x32_bf16 v[216:219], v[228:231], v[96:99], v[216:219]
    v_mfma_f32_16x16x32_bf16 v[220:223], v[228:231], v[100:103], v[220:223]
    v_mfma_f32_16x16x32_bf16 v[212:215], v[232:235], v[104:107], v[212:215]
    v_mfma_f32_16x16x32_bf16 v[216:219], v[232:235], v[108:111], v[216:219]
    s_waitcnt vmcnt(12)
    v_mfma_f32_16x16x32_bf16 v[220:223], v[232:235], v[112:115], v[220:223]
    s_waitcnt vmcnt(11)
    v_mfma_f32_16x16x32_bf16 v[212:215], v[236:239], v[116:119], v[212:215]
    s_waitcnt vmcnt(10)
    v_mfma_f32_16x16x32_bf16 v[216:219], v[236:239], v[120:123], v[216:219]
    s_waitcnt vmcnt(9)
    v_mfma_f32_16x16x32_bf16 v[220:223], v[236:239], v[124:127], v[220:223]
    s_mov_b32 exec_lo, 0x00ff00ff
    s_mov_b32 exec_hi, 0xff00ff00
    s_nop 1
    ds_write_b32 v19, v212 offset:0
    ds_write_b32 v19, v213 offset:48
    ds_write_b32 v19, v214 offset:96
    ds_write_b32 v19, v215 offset:144
    ds_write_b32 v20, v216 offset:0
    ds_write_b32 v20, v217 offset:48
    ds_write_b32 v20, v218 offset:96
    ds_write_b32 v20, v219 offset:144
    ds_write_b32 v21, v220 offset:0
    ds_write_b32 v21, v221 offset:48
    ds_write_b32 v21, v222 offset:96
    ds_write_b32 v21, v223 offset:144
    s_mov_b64 exec, -1
    s_waitcnt lgkmcnt(0)
    s_barrier
    ds_read_b32 v248, v255
    ds_read_b128 v[240:243], v22
    ds_read_b128 v[244:247], v22 offset:1680
    s_waitcnt lgkmcnt(2)
    v_max_f32_dpp v249, v248, v248 quad_perm:[1,0,3,2] row_mask:0xf bank_mask:0xf
    s_nop 1
    v_max_f32_dpp v249, v249, v249 quad_perm:[2,3,0,1] row_mask:0xf bank_mask:0xf
    s_nop 1
    v_max_f32_dpp v249, v249, v249 row_half_mirror row_mask:0xf bank_mask:0xf
    v_sub_f32 v248, v248, v249
    v_mul_f32 v248, 0x3fb8aa3b, v248
    v_exp_f32 v248, v248
    s_waitcnt lgkmcnt(0)
    v_add_f32 v240, v240, v244
    v_add_f32 v241, v241, v245
    v_add_f32 v242, v242, v246
    v_add_f32 v243, v243, v247
    v_mul_f32 v240, v240, v248
    v_mul_f32 v241, v241, v248
    v_mul_f32 v242, v242, v248
    v_mul_f32 v243, v243, v248
    v_add_f32_dpp v240, v240, v240 quad_perm:[1,0,3,2] row_mask:0xf bank_mask:0xf
    v_add_f32_dpp v241, v241, v241 quad_perm:[1,0,3,2] row_mask:0xf bank_mask:0xf
    v_add_f32_dpp v242, v242, v242 quad_perm:[1,0,3,2] row_mask:0xf bank_mask:0xf
    v_add_f32_dpp v243, v243, v243 quad_perm:[1,0,3,2] row_mask:0xf bank_mask:0xf
    v_add_f32_dpp v240, v240, v240 quad_perm:[2,3,0,1] row_mask:0xf bank_mask:0xf
    v_add_f32_dpp v241, v241, v241 quad_perm:[2,3,0,1] row_mask:0xf bank_mask:0xf
    v_add_f32_dpp v242, v242, v242 quad_perm:[2,3,0,1] row_mask:0xf bank_mask:0xf
    v_add_f32_dpp v243, v243, v243 quad_perm:[2,3,0,1] row_mask:0xf bank_mask:0xf
    v_add_f32_dpp v240, v240, v240 row_half_mirror row_mask:0xf bank_mask:0xf
    v_add_f32_dpp v241, v241, v241 row_half_mirror row_mask:0xf bank_mask:0xf
    v_add_f32_dpp v242, v242, v242 row_half_mirror row_mask:0xf bank_mask:0xf
    v_add_f32_dpp v243, v243, v243 row_half_mirror row_mask:0xf bank_mask:0xf
    v_cndmask_b32 v242, v242, v249, s[88:89]
    v_bfi_b32 v240, v11, s74, v240
    v_bfi_b32 v241, v11, s74, v241
    v_bfi_b32 v242, v11, s75, v242
    v_bfi_b32 v243, v11, s75, v243
    buffer_store_dwordx4 v[240:243], v25, s[48:51], s82 offen
    buffer_store_dwordx4 v[240:243], v17, s[48:51], s90 offen sc1
    s_cmp_lg_u32 s91, 0
    s_cbranch_scc1 L_rm_10
    buffer_load_dwordx4 v[128:131], v18, s[48:51], s83 offen nt
    buffer_load_dwordx4 v[132:135], v18, s[48:51], s83 offen offset:128 nt
    s_branch L_jn_11
L_rm_10:
    buffer_load_dwordx4 v[128:131], v18, s[48:51], s83 offen sc1
    buffer_load_dwordx4 v[132:135], v18, s[48:51], s83 offen offset:16 sc1
L_jn_11:
    s_lshl_b32 s76, s63, 5
    s_add_u32 s76, s76, 448
    v_lshl_add_u32 v27, v1, 1, s76
    ds_read_u16 v200, v27 offset:0
    ds_read_u16 v202, v27 offset:128
    ds_read_u16 v201, v27 offset:16
    ds_read_u16 v203, v27 offset:144
    s_waitcnt lgkmcnt(0)
    v_lshlrev_b32 v200, 16, v200
    v_lshlrev_b32 v201, 16, v201
    v_lshlrev_b32 v202, 16, v202
    v_lshlrev_b32 v203, 16, v203
    v_cmp_lt_f32 vcc, 0, v200
    s_nop 1
    v_cndmask_b32 v204, 0, 1.0, vcc
    v_cmp_lt_f32 vcc, 0, v201
    s_nop 1
    v_cndmask_b32 v205, 0, 1.0, vcc
    v_mul_f32 v200, v200, v204
    v_mul_f32 v201, v201, v205
    v_mul_f32 v200, v200, v202
    v_mul_f32 v201, v201, v203
    v_cvt_pk_bf16_f32 v200, v200, v200
    v_cvt_pk_bf16_f32 v201, v201, v201
    v_and_b32 v144, v200, v4
    v_and_b32 v145, v200, v5
    v_and_b32 v146, v200, v6
    v_and_b32 v147, v200, v7
    v_and_b32 v148, v201, v4
    v_and_b32 v149, v201, v5
    v_and_b32 v150, v201, v6
    v_and_b32 v151, v201, v7
    s_waitcnt vmcnt(12)
    v_mfma_f32_16x16x32_bf16 v[152:155], v[144:147], v[168:171], 0
    s_waitcnt vmcnt(11)
    v_mfma_f32_16x16x32_bf16 v[152:155], v[148:151], v[172:175], v[152:155]
    s_nop 7
    v_permlane32_swap_b32 v152, v154
    v_permlane32_swap_b32 v153, v155
    s_nop 0
    v_add_f32_dpp v200, v154, v152 row_ror:8 row_mask:0xf bank_mask:0xf
    v_add_f32_dpp v201, v155, v153 row_ror:8 row_mask:0xf bank_mask:0xf
    s_nop 0
    v_permlane32_swap_b32 v200, v202
    v_permlane32_swap_b32 v201, v203
    v_bfi_b32 v200, v11, s74, v200
    v_bfi_b32 v201, v11, s74, v201
    v_bfi_b32 v202, v11, s75, v202
    v_bfi_b32 v203, v11, s75, v203
    buffer_store_dwordx4 v[200:203], v16, s[48:51], s85 offen sc1
    s_waitcnt vmcnt(6)
    s_cmp_lg_u32 s91, 0
    s_cbranch_scc1 L_rm_12
    buffer_load_dwordx4 v[136:139], v18, s[48:51], s83 offen nt
    buffer_load_dwordx4 v[140:143], v18, s[48:51], s83 offen offset:128 nt
    s_waitcnt vmcnt(3)
    v_bitop3_b32 v27, v128, v129, s74 bitop3:0x7e
    v_bitop3_b32 v28, v132, v133, s74 bitop3:0x7e
    v_bitop3_b32 v29, v130, v131, s75 bitop3:0x7e
    v_bitop3_b32 v30, v134, v135, s75 bitop3:0x7e
    v_or3_b32 v27, v27, v28, v29
    v_bitop3_b32 v27, v27, v30, v11 bitop3:0xa8
    v_cmp_ne_u32 vcc, 0, v27
    s_nop 0
    s_cbranch_vccz L_u0_15
    s_mov_b32 s86, 0
L_rt_14:
    buffer_load_dwordx4 v[128:131], v18, s[48:51], s83 offen sc1
    buffer_load_dwordx4 v[132:135], v18, s[48:51], s83 offen offset:128 sc1
    s_waitcnt vmcnt(2)
    v_bitop3_b32 v27, v136, v137, s74 bitop3:0x7e
    v_bitop3_b32 v28, v140, v141, s74 bitop3:0x7e
    v_bitop3_b32 v29, v138, v139, s75 bitop3:0x7e
    v_bitop3_b32 v30, v142, v143, s75 bitop3:0x7e
    v_or3_b32 v27, v27, v28, v29
    v_bitop3_b32 v27, v27, v30, v11 bitop3:0xa8
    v_cmp_ne_u32 vcc, 0, v27
    s_nop 0
    s_cbranch_vccz L_u1_16
    buffer_load_dwordx4 v[136:139], v18, s[48:51], s83 offen sc1
    buffer_load_dwordx4 v[140:143], v18, s[48:51], s83 offen offset:128 sc1
    s_waitcnt vmcnt(2)
    v_bitop3_b32 v27, v128, v129, s74 bitop3:0x7e
    v_bitop3_b32 v28, v132, v133, s74 bitop3:0x7e
    v_bitop3_b32 v29, v130, v131, s75 bitop3:0x7e
    v_bitop3_b32 v30, v134, v135, s75 bitop3:0x7e
    v_or3_b32 v27, v27, v28, v29
    v_bitop3_b32 v27, v27, v30, v11 bitop3:0xa8
    v_cmp_ne_u32 vcc, 0, v27
    s_add_u32 s86, s86, 1
    s_cmp_gt_u32 s86, 65536
    s_cbranch_scc1 L_u0_15
    s_cbranch_vccnz L_rt_14
L_u0_15:
    v_bfi_b32 v162, v11, 0, v134
    v_bfi_b32 v156, v11, v12, v128
    v_bfi_b32 v157, v11, v12, v129
    v_bfi_b32 v158, v11, v12, v130
    v_bfi_b32 v159, v11, v12, v131
    v_bfi_b32 v160, v11, v12, v132
    v_bfi_b32 v161, v11, v12, v133
    v_bfi_b32 v163, v11, v12, v135
    s_branch L_dn_17
L_u1_16:
    v_bfi_b32 v162, v11, 0, v142
    v_bfi_b32 v156, v11, v12, v136
    v_bfi_b32 v157, v11, v12, v137
    v_bfi_b32 v158, v11, v12, v138
    v_bfi_b32 v159, v11, v12, v139
    v_bfi_b32 v160, v11, v12, v140
    v_bfi_b32 v161, v11, v12, v141
    v_bfi_b32 v163, v11, v12, v143
L_dn_17:
    s_branch L_jn_13
L_rm_12:
    buffer_load_dwordx4 v[136:139], v18, s[48:51], s83 offen sc1
    buffer_load_dwordx4 v[140:143], v18, s[48:51], s83 offen offset:16 sc1
    s_waitcnt vmcnt(3)
    v_bitop3_b32 v27, v128, v129, s74 bitop3:0x7e
    v_bitop3_b32 v28, v132, v133, s74 bitop3:0x7e
    v_bitop3_b32 v29, v130, v131, s75 bitop3:0x7e
    v_bitop3_b32 v30, v134, v135, s75 bitop3:0x7e
    v_or3_b32 v27, v27, v28, v29
    v_bitop3_b32 v27, v27, v30, v11 bitop3:0xa8
    v_cmp_ne_u32 vcc, 0, v27
    s_nop 0
    s_cbranch_vccz L_u0_19
    s_mov_b32 s86, 0
L_rt_18:
    buffer_load_dwordx4 v[128:131], v18, s[48:51], s83 offen sc1
    buffer_load_dwordx4 v[132:135], v18, s[48:51], s83 offen offset:16 sc1
    s_waitcnt vmcnt(2)
    v_bitop3_b32 v27, v136, v137, s74 bitop3:0x7e
    v_bitop3_b32 v28, v140, v141, s74 bitop3:0x7e
    v_bitop3_b32 v29, v138, v139, s75 bitop3:0x7e
    v_bitop3_b32 v30, v142, v143, s75 bitop3:0x7e
    v_or3_b32 v27, v27, v28, v29
    v_bitop3_b32 v27, v27, v30, v11 bitop3:0xa8
    v_cmp_ne_u32 vcc, 0, v27
    s_nop 0
    s_cbranch_vccz L_u1_20
    buffer_load_dwordx4 v[136:139], v18, s[48:51], s83 offen sc1
    buffer_load_dwordx4 v[140:143], v18, s[48:51], s83 offen offset:16 sc1
    s_waitcnt vmcnt(2)
    v_bitop3_b32 v27, v128, v129, s74 bitop3:0x7e
    v_bitop3_b32 v28, v132, v133, s74 bitop3:0x7e
    v_bitop3_b32 v29, v130, v131, s75 bitop3:0x7e
    v_bitop3_b32 v30, v134, v135, s75 bitop3:0x7e
    v_or3_b32 v27, v27, v28, v29
    v_bitop3_b32 v27, v27, v30, v11 bitop3:0xa8
    v_cmp_ne_u32 vcc, 0, v27
    s_add_u32 s86, s86, 1
    s_cmp_gt_u32 s86, 65536
    s_cbranch_scc1 L_u0_19
    s_cbranch_vccnz L_rt_18
L_u0_19:
    v_bfi_b32 v162, v11, 0, v134
    v_bfi_b32 v156, v11, v12, v128
    v_bfi_b32 v157, v11, v12, v129
    v_bfi_b32 v158, v11, v12, v130
    v_bfi_b32 v159, v11, v12, v131
    v_bfi_b32 v160, v11, v12, v132
    v_bfi_b32 v161, v11, v12, v133
    v_bfi_b32 v163, v11, v12, v135
    s_branch L_dn_21
L_u1_20:
    v_bfi_b32 v162, v11, 0, v142
    v_bfi_b32 v156, v11, v12, v136
    v_bfi_b32 v157, v11, v12, v137
    v_bfi_b32 v158, v11, v12, v138
    v_bfi_b32 v159, v11, v12, v139
    v_bfi_b32 v160, v11, v12, v140
    v_bfi_b32 v161, v11, v12, v141
    v_bfi_b32 v163, v11, v12, v143
L_dn_21:
L_jn_13:
    v_max_f32_dpp v27, v162, v162 quad_perm:[1,0,3,2] row_mask:0xf bank_mask:0xf
    s_nop 1
    v_max_f32_dpp v27, v27, v27 quad_perm:[2,3,0,1] row_mask:0xf bank_mask:0xf
    s_nop 1
    v_max_f32_dpp v27, v27, v27 row_half_mirror row_mask:0xf bank_mask:0xf
    v_sub_f32 v162, v162, v27
    v_mul_f32 v162, 0x3fb8aa3b, v162
    v_exp_f32 v162, v162
    s_nop 0
    v_mul_f32 v163, v163, v162
    v_mul_f32 v156, v156, v162
    v_mul_f32 v157, v157, v162
    v_mul_f32 v158, v158, v162
    v_mul_f32 v159, v159, v162
    v_mul_f32 v160, v160, v162
    v_mul_f32 v161, v161, v162
    v_add_f32_dpp v163, v163, v163 quad_perm:[1,0,3,2] row_mask:0xf bank_mask:0xf
    v_add_f32_dpp v156, v156, v156 quad_perm:[1,0,3,2] row_mask:0xf bank_mask:0xf
    v_add_f32_dpp v157, v157, v157 quad_perm:[1,0,3,2] row_mask:0xf bank_mask:0xf
    v_add_f32_dpp v158, v158, v158 quad_perm:[1,0,3,2] row_mask:0xf bank_mask:0xf
    v_add_f32_dpp v159, v159, v159 quad_perm:[1,0,3,2] row_mask:0xf bank_mask:0xf
    v_add_f32_dpp v160, v160, v160 quad_perm:[1,0,3,2] row_mask:0xf bank_mask:0xf
    v_add_f32_dpp v161, v161, v161 quad_perm:[1,0,3,2] row_mask:0xf bank_mask:0xf
    v_add_f32_dpp v163, v163, v163 quad_perm:[2,3,0,1] row_mask:0xf bank_mask:0xf
    v_add_f32_dpp v156, v156, v156 quad_perm:[2,3,0,1] row_mask:0xf bank_mask:0xf
    v_add_f32_dpp v157, v157, v157 quad_perm:[2,3,0,1] row_mask:0xf bank_mask:0xf
    v_add_f32_dpp v158, v158, v158 quad_perm:[2,3,0,1] row_mask:0xf bank_mask:0xf
    v_add_f32_dpp v159, v159, v159 quad_perm:[2,3,0,1] row_mask:0xf bank_mask:0xf
    v_add_f32_dpp v160, v160, v160 quad_perm:[2,3,0,1] row_mask:0xf bank_mask:0xf
    v_add_f32_dpp v161, v161, v161 quad_perm:[2,3,0,1] row_mask:0xf bank_mask:0xf
    v_add_f32_dpp v163, v163, v163 row_half_mirror row_mask:0xf bank_mask:0xf
    v_add_f32_dpp v156, v156, v156 row_half_mirror row_mask:0xf bank_mask:0xf
    v_add_f32_dpp v157, v157, v157 row_half_mirror row_mask:0xf bank_mask:0xf
    v_add_f32_dpp v158, v158, v158 row_half_mirror row_mask:0xf bank_mask:0xf
    v_add_f32_dpp v159, v159, v159 row_half_mirror row_mask:0xf bank_mask:0xf
    v_add_f32_dpp v160, v160, v160 row_half_mirror row_mask:0xf bank_mask:0xf
    v_add_f32_dpp v161, v161, v161 row_half_mirror row_mask:0xf bank_mask:0xf
    v_rcp_f32 v163, v163
    s_nop 0
    v_mul_f32 v156, v156, v163
    v_mul_f32 v157, v157, v163
    v_mul_f32 v158, v158, v163
    v_mul_f32 v159, v159, v163
    v_mul_f32 v160, v160, v163
    v_mul_f32 v161, v161, v163
    v_cvt_pk_bf16_f32 v156, v156, v156
    v_cvt_pk_bf16_f32 v157, v157, v157
    v_cvt_pk_bf16_f32 v158, v158, v158
    v_cvt_pk_bf16_f32 v159, v159, v159
    v_cvt_pk_bf16_f32 v160, v160, v160
    v_cvt_pk_bf16_f32 v161, v161, v161
    v_and_b32 v224, v156, v4
    v_and_b32 v225, v156, v5
    v_and_b32 v226, v156, v6
    v_and_b32 v227, v156, v7
    v_and_b32 v228, v157, v4
    v_and_b32 v229, v157, v5
    v_and_b32 v230, v157, v6
    v_and_b32 v231, v157, v7
    v_mfma_f32_16x16x32_bf16 v[212:215], v[224:227], v[176:179], 0
    v_and_b32 v232, v158, v4
    v_and_b32 v233, v158, v5
    v_and_b32 v234, v158, v6
    v_and_b32 v235, v158, v7
    v_mfma_f32_16x16x32_bf16 v[212:215], v[228:231], v[180:183], v[212:215]
    v_and_b32 v236, v159, v4
    v_and_b32 v237, v159, v5
    v_and_b32 v238, v159, v6
    v_and_b32 v239, v159, v7
    v_mfma_f32_16x16x32_bf16 v[212:215], v[232:235], v[184:187], v[212:215]
    v_and_b32 v224, v160, v4
    v_and_b32 v225, v160, v5
    v_and_b32 v226, v160, v6
    v_and_b32 v227, v160, v7
    v_mfma_f32_16x16x32_bf16 v[212:215], v[236:239], v[188:191], v[212:215]
    v_and_b32 v228, v161, v4
    v_and_b32 v229, v161, v5
    v_and_b32 v230, v161, v6
    v_and_b32 v231, v161, v7
    v_mfma_f32_16x16x32_bf16 v[212:215], v[224:227], v[192:195], v[212:215]
    s_nop 0
    v_mfma_f32_16x16x32_bf16 v[212:215], v[228:231], v[196:199], v[212:215]
    s_nop 7
    v_permlane32_swap_b32 v212, v214
    v_permlane32_swap_b32 v213, v215
    s_nop 0
    v_add_f32_dpp v240, v214, v212 row_ror:8 row_mask:0xf bank_mask:0xf
    v_add_f32_dpp v241, v215, v213 row_ror:8 row_mask:0xf bank_mask:0xf
    s_nop 0
    v_permlane32_swap_b32 v240, v242
    v_permlane32_swap_b32 v241, v243
    v_bfi_b32 v240, v11, s74, v240
    v_bfi_b32 v241, v11, s74, v241
    v_bfi_b32 v242, v11, s75, v242
    v_bfi_b32 v243, v11, s75, v243
    buffer_store_dwordx4 v[240:243], v16, s[48:51], s84 offen sc1
    s_cmp_eq_u32 s3, 0
    s_cbranch_scc0 L_nd_22
    v_mov_b32 v27, 1
    ds_write_b32 v26, v27 offset:24
L_nd_22:
    s_endpgm
L_roleB:
    s_mul_i32 s65, s60, 3145728
    s_lshl_b32 s76, s61, 8
    s_lshl_b32 s77, s3, 5
    s_add_u32 s76, s76, s77
    s_add_u32 s76, s76, 6144
    s_mul_i32 s76, s76, 384
    s_add_u32 s65, s65, s76
    s_add_u32 s66, s65, 3072
    s_add_u32 s67, s65, 6144
    s_add_u32 s68, s65, 9216
    v_mul_u32_u24 v8, 384, v1
    v_add_u32 v8, v8, v2
    v_lshlrev_b32 v27, 4, v0
    v_lshlrev_b32 v29, 2, v0
    s_waitcnt lgkmcnt(0)
    s_load_dword s73, s[26:27], 0
    s_mov_b32 s52, s4
    s_and_b32 s53, s5, 0xffff
    s_mov_b32 s54, 1280
    s_mov_b32 s55, 0x20000
    s_cmp_eq_u32 s3, 5
    s_cbranch_scc0 L_nx_23
    buffer_load_dwordx4 v[240:243], v27, s[52:55], 0 offen
    buffer_load_dword v244, v29, s[52:55], 0 offen offset:1024
L_nx_23:
    s_mov_b32 s28, s6
    s_and_b32 s29, s7, 0xffff
    s_mov_b32 s30, 100663296
    s_mov_b32 s31, 0x20000
    s_mov_b32 s32, s8
    s_and_b32 s33, s9, 0xffff
    s_mov_b32 s34, 100663296
    s_mov_b32 s35, 0x20000
    s_mov_b32 s48, s26
    s_and_b32 s49, s27, 0xffff
    s_mov_b32 s50, 4194304
    s_mov_b32 s51, 0x20000
    s_mov_b32 s56, s22
    s_and_b32 s57, s23, 0xffff
    s_mov_b32 s58, 1280
    s_mov_b32 s59, 0x20000
    s_cmp_eq_u32 s3, 6
    s_cbranch_scc0 L_ni_24
    s_getreg_b32 s92, hwreg(HW_REG_XCC_ID, 0, 4)
    s_lshl_b32 s76, s60, 3
    s_add_u32 s76, s76, s61
    s_lshl_b32 s76, s76, 7
    s_add_u32 s76, s76, 1576960
    v_mov_b32 v28, 0x80000000
    v_cmp_gt_u32 vcc, 8, v0
    s_nop 1
    v_cndmask_b32 v28, v28, v27, vcc
    s_waitcnt lgkmcnt(0)
    s_add_u32 s77, s73, 1
    v_mov_b32 v200, s77
    v_mov_b32 v201, s92
    v_mov_b32 v202, s77
    v_mov_b32 v203, s92
    buffer_store_dwordx4 v[200:203], v28, s[48:51], s76 offen sc1
L_ni_24:
    s_barrier
    buffer_load_dwordx4 v[32:35], v8, s[28:31], s65 offen offset:0 nt
    buffer_load_dwordx4 v[36:39], v8, s[28:31], s65 offen offset:128 nt
    buffer_load_dwordx4 v[40:43], v8, s[28:31], s65 offen offset:256 nt
    buffer_load_dwordx4 v[44:47], v8, s[28:31], s66 offen offset:0 nt
    s_cmp_eq_u32 s3, 5
    s_cbranch_scc0 L_nl_25
    s_waitcnt vmcnt(4)
    v_lshlrev_b32 v27, 4, v0
    v_add_u32 v27, 768, v27
    v_lshlrev_b32 v28, 2, v0
    v_add_u32 v29, 1792, v28
    ds_write_b128 v27, v[240:243]
    ds_write_b32 v29, v244
    s_mul_i32 s76, s61, 160
    s_add_u32 s76, s76, 768
    v_lshl_add_u32 v29, v0, 1, s76
    ds_read_u16 v246, v29
    ds_read_u16 v247, v29 offset:128
    v_lshlrev_b32 v224, 16, v240
    v_and_b32 v225, 0xffff0000, v240
    v_lshlrev_b32 v226, 16, v241
    v_and_b32 v227, 0xffff0000, v241
    v_lshlrev_b32 v228, 16, v242
    v_and_b32 v229, 0xffff0000, v242
    v_lshlrev_b32 v230, 16, v243
    v_and_b32 v231, 0xffff0000, v243
    v_lshlrev_b32 v232, 16, v244
    v_and_b32 v233, 0xffff0000, v244
    v_add_f32 v30, v224, v225
    v_add_f32 v31, v226, v227
    v_add_f32 v30, v30, v228
    v_add_f32 v31, v31, v229
    v_add_f32 v30, v30, v230
    v_add_f32 v31, v31, v231
    v_add_f32 v30, v30, v232
    v_add_f32 v31, v31, v233
    v_add_f32 v30, v30, v31
    s_nop 1
    v_add_f32_dpp v30, v30, v30 row_ror:8 row_mask:0xf bank_mask:0xf
    s_nop 1
    v_add_f32_dpp v30, v30, v30 row_ror:4 row_mask:0xf bank_mask:0xf
    s_nop 1
    v_add_f32_dpp v30, v30, v30 row_ror:2 row_mask:0xf bank_mask:0xf
    s_nop 1
    v_add_f32_dpp v30, v30, v30 row_ror:1 row_mask:0xf bank_mask:0xf
    v_mov_b32 v31, v30
    s_nop 1
    v_permlane16_swap_b32 v31, v30
    v_add_f32 v30, v30, v31
    v_mov_b32 v31, v30
    s_nop 1
    v_permlane32_swap_b32 v31, v30
    v_add_f32 v30, v30, v31
    v_mul_f32 v27, 0x3acccccd, v30
    v_sub_f32 v224, v224, v27
    v_sub_f32 v225, v225, v27
    v_sub_f32 v226, v226, v27
    v_sub_f32 v227, v227, v27
    v_sub_f32 v228, v228, v27
    v_sub_f32 v229, v229, v27
    v_sub_f32 v230, v230, v27
    v_sub_f32 v231, v231, v27
    v_sub_f32 v232, v232, v27
    v_sub_f32 v233, v233, v27
    v_mul_f32 v30, v224, v224
    v_mul_f32 v31, v225, v225
    v_fmac_f32 v30, v226, v226
    v_fmac_f32 v31, v227, v227
    v_fmac_f32 v30, v228, v228
    v_fmac_f32 v31, v229, v229
    v_fmac_f32 v30, v230, v230
    v_fmac_f32 v31, v231, v231
    v_fmac_f32 v30, v232, v232
    v_fmac_f32 v31, v233, v233
    v_add_f32 v30, v30, v31
    s_nop 1
    v_add_f32_dpp v30, v30, v30 row_ror:8 row_mask:0xf bank_mask:0xf
    s_nop 1
    v_add_f32_dpp v30, v30, v30 row_ror:4 row_mask:0xf bank_mask:0xf
    s_nop 1
    v_add_f32_dpp v30, v30, v30 row_ror:2 row_mask:0xf bank_mask:0xf
    s_nop 1
    v_add_f32_dpp v30, v30, v30 row_ror:1 row_mask:0xf bank_mask:0xf
    v_mov_b32 v31, v30
    s_nop 1
    v_permlane16_swap_b32 v31, v30
    v_add_f32 v30, v30, v31
    v_mov_b32 v31, v30
    s_nop 1
    v_permlane32_swap_b32 v31, v30
    v_add_f32 v30, v30, v31
    v_mul_f32 v30, 0x3acccccd, v30
    v_cvt_pk_bf16_f32 v30, v30, v30
    v_and_b32 v30, 0xffff0000, v30
    v_add_f32 v30, 0x3727c5ac, v30
    v_cvt_pk_bf16_f32 v30, v30, v30
    v_and_b32 v30, 0xffff0000, v30
    v_sqrt_f32 v30, v30
    s_nop 0
    v_cvt_pk_bf16_f32 v30, v30, v30
    v_and_b32 v30, 0xffff0000, v30
    v_rcp_f32 v29, v30
    v_cvt_pk_bf16_f32 v31, v27, v27
    v_and_b32 v31, 0xffff0000, v31
    s_waitcnt lgkmcnt(0)
    v_lshlrev_b32 v246, 16, v246
    v_lshlrev_b32 v247, 16, v247
    v_sub_f32 v246, v246, v31
    v_sub_f32 v247, v247, v31
    v_cvt_pk_bf16_f32 v246, v246, v246
    v_cvt_pk_bf16_f32 v247, v247, v247
    v_and_b32 v246, 0xffff0000, v246
    v_and_b32 v247, 0xffff0000, v247
    v_mul_f32 v224, v246, v29
    v_mul_f32 v225, v247, v29
    v_fma_f32 v246, -v224, v30, v246
    v_fma_f32 v247, -v225, v30, v247
    v_fma_f32 v224, v246, v29, v224
    v_fma_f32 v225, v247, v29, v225
    v_cvt_pk_bf16_f32 v224, v224, v224
    v_cvt_pk_bf16_f32 v225, v225, v225
    v_add_u32 v28, 2048, v28
    ds_write_b32 v28, v224
    s_mov_b64 exec, 0xffff
    ds_write_b32 v28, v225 offset:256
    s_mov_b64 exec, -1
    v_mov_b32 v27, 1
    ds_write_b32 v26, v27 offset:20
L_nl_25:
    s_cmp_eq_u32 s3, 7
    s_cbranch_scc0 L_nopf_26
    s_cmp_eq_u32 s61, 0
    s_cbranch_scc0 L_nopf_26
    s_getpc_b64 s[36:37]
L_pc:
    s_sub_u32 s36, s36, L_pc-recurrent_scan__sliding_block_cached__glu_gated_reglu__decode_kernel
    s_subb_u32 s37, s37, 0
    s_and_b32 s37, s37, 0xffff
    s_mov_b32 s38, L_code_end-recurrent_scan__sliding_block_cached__glu_gated_reglu__decode_kernel
    s_mov_b32 s39, 0x20000
    v_lshlrev_b32 v28, 4, v0
    s_movk_i32 s76, 0x200
L_pf_27:
    buffer_load_dwordx4 v[168:171], v28, s[36:39], s76 offen
    s_add_u32 s76, s76, 1024
    s_cmp_lt_u32 s76, L_code_end-recurrent_scan__sliding_block_cached__glu_gated_reglu__decode_kernel
    s_cbranch_scc1 L_pf_27
L_nopf_26:
    s_lshl_b32 s62, s60, 3
    s_add_u32 s62, s62, s61
    s_lshr_b32 s63, s61, 1
    s_and_b32 s64, s61, 1
    s_lshl_b32 s93, s60, 10
    s_add_u32 s93, s93, 1576960
    s_getreg_b32 s92, hwreg(HW_REG_XCC_ID, 0, 4)
    v_and_b32 v204, 1, v0
    v_cmp_eq_u32 vcc, 1, v204
    v_mov_b32 v205, 0xffff
    v_mov_b32 v206, 0xffff0000
    v_cndmask_b32 v207, v205, v206, vcc
    v_bfe_u32 v204, v0, 1, 2
    v_cmp_eq_u32 vcc, 0, v204
    s_nop 1
    v_cndmask_b32 v4, 0, v207, vcc
    v_cmp_eq_u32 vcc, 1, v204
    s_nop 1
    v_cndmask_b32 v5, 0, v207, vcc
    v_cmp_eq_u32 vcc, 2, v204
    s_nop 1
    v_cndmask_b32 v6, 0, v207, vcc
    v_cmp_eq_u32 vcc, 3, v204
    s_nop 1
    v_cndmask_b32 v7, 0, v207, vcc
    v_mov_b32 v11, 0x3ff
    v_mov_b32 v12, 0x200
    v_add_u32 v13, 64, v2
    s_lshl_b32 s76, s62, 10
    s_lshl_b32 s77, s3, 7
    s_add_u32 s76, s76, s77
    s_add_u32 s90, s76, 659456
    s_lshl_b32 s76, s60, 13
    s_lshl_b32 s77, s3, 10
    s_add_u32 s76, s76, s77
    s_lshl_b32 s77, s61, 4
    s_add_u32 s76, s76, s77
    s_add_u32 s82, s76, 3866624
    v_and_b32 v204, 7, v0
    v_bfe_u32 v205, v0, 4, 1
    v_lshrrev_b32 v206, 5, v0
    v_mov_b32 v3, 0x80000000
    v_lshlrev_b32 v17, 4, v1
    v_lshlrev_b32 v18, 7, v1
    v_cmp_eq_u32 vcc, 0, v204
    s_nop 1
    v_cndmask_b32 v17, v3, v17, vcc
    v_cndmask_b32 v18, v3, v18, vcc
    s_sub_u32 s76, s3, 5
    s_lshl_b32 s84, s76, 1
    s_add_u32 s85, s84, 1
    s_mul_i32 s76, s60, 20480
    s_lshl_b32 s77, s84, 9
    s_add_u32 s80, s76, s77
    s_add_u32 s81, s80, 512
    s_cmp_eq_u32 s3, 7
    s_cselect_b32 s81, 0x7f000000, s81
    v_and_b32 v208, 31, v0
    v_mul_u32_u24 v15, 2560, v206
    v_lshl_add_u32 v15, v208, 4, v15
    v_lshl_add_u32 v25, v208, 1, v206
    v_lshlrev_b32 v25, 1, v25
    v_add_u32 v25, 64, v25
    s_lshl_b32 s76, s3, 1
    v_add_u32 v208, s76, v206
    v_mul_u32_u24 v208, 420, v208
    v_add_u32 v23, 6, v208
    v_mul_u32_u24 v3, 48, v205
    v_add_u32 v208, v208, v3
    v_add_u32 v19, 0, v204
    v_mul_u32_u24 v3, 43, v19
    v_lshrrev_b32 v3, 8, v3
    v_mul_u32_u24 v3, 98, v3
    v_add3_u32 v19, v19, v3, v208
    v_lshlrev_b32 v19, 2, v19
    v_add_u32 v19, 2432, v19
    v_add_u32 v20, 8, v204
    v_mul_u32_u24 v3, 43, v20
    v_lshrrev_b32 v3, 8, v3
    v_mul_u32_u24 v3, 98, v3
    v_add3_u32 v20, v20, v3, v208
    v_lshlrev_b32 v20, 2, v20
    v_add_u32 v20, 2432, v20
    v_add_u32 v21, 16, v204
    v_mul_u32_u24 v3, 43, v21
    v_lshrrev_b32 v3, 8, v3
    v_mul_u32_u24 v3, 98, v3
    v_add3_u32 v21, v21, v3, v208
    v_lshlrev_b32 v21, 2, v21
    v_add_u32 v21, 2432, v21
    v_mul_u32_u24 v22, 840, v204
    s_lshr_b32 s76, s3, 1
    s_mul_i32 s76, s76, 104
    s_and_b32 s77, s3, 1
    s_mul_i32 s77, s77, 48
    s_add_u32 s76, s76, s77
    v_lshrrev_b32 v3, 4, v0
    v_mul_u32_u24 v3, 12, v3
    v_add3_u32 v22, v22, v3, s76
    v_bfe_u32 v3, v0, 3, 1
    v_lshl_add_u32 v22, v3, 2, v22
    v_lshlrev_b32 v22, 2, v22
    v_add_u32 v22, 2432, v22
    s_mov_b32 s88, 0xff00ff00
    s_mov_b32 s89, 0xff00ff00
    v_lshlrev_b32 v255, 2, v204
    v_add_u32 v255, 32, v255
    v_bfe_u32 v3, v0, 3, 2
    v_mul_u32_u24 v3, 104, v3
    v_add_u32 v23, v23, v3
    v_mul_u32_u24 v3, 12, v204
    v_add_u32 v23, v23, v3
    v_lshlrev_b32 v23, 2, v23
    v_add_u32 v23, 2432, v23
    s_waitcnt lgkmcnt(0)
    s_add_u32 s73, s73, 1
    s_and_b32 s74, s73, 0x3ff
    s_lshr_b32 s76, s73, 10
    s_add_u32 s76, s76, s73
    s_and_b32 s75, s76, 0x3ff
    v_and_b32 v31, 7, v0
    v_lshlrev_b32 v31, 7, v31
    buffer_load_dwordx2 v[210:211], v31, s[48:51], s93 offen sc1
    s_waitcnt vmcnt(3)
    buffer_load_dwordx4 v[48:51], v8, s[28:31], s66 offen offset:128 nt
    s_waitcnt vmcnt(3)
    buffer_load_dwordx4 v[52:55], v8, s[28:31], s66 offen offset:256 nt
    s_waitcnt vmcnt(3)
    buffer_load_dwordx4 v[56:59], v8, s[28:31], s67 offen offset:0 nt
    s_waitcnt vmcnt(3)
    buffer_load_dwordx4 v[60:63], v8, s[28:31], s67 offen offset:128 nt
    s_waitcnt vmcnt(3)
    buffer_load_dwordx4 v[64:67], v8, s[28:31], s67 offen offset:256 nt
    s_waitcnt vmcnt(3)
    buffer_load_dwordx4 v[68:71], v8, s[28:31], s68 offen offset:0 nt
    s_waitcnt vmcnt(3)
    buffer_load_dwordx4 v[72:75], v8, s[28:31], s68 offen offset:128 nt
    s_waitcnt vmcnt(3)
    buffer_load_dwordx4 v[76:79], v8, s[28:31], s68 offen offset:256 nt
    s_waitcnt vmcnt(3)
    v_cmp_ne_u32 vcc, s73, v210
    s_nop 0
    s_cbranch_vccz L_ok_28
    s_mov_b32 s86, 0
L_rt_29:
    v_and_b32 v31, 7, v0
    v_lshlrev_b32 v31, 7, v31
    buffer_load_dwordx2 v[210:211], v31, s[48:51], s93 offen sc1
    s_waitcnt vmcnt(0)
    v_cmp_ne_u32 vcc, s73, v210
    s_add_u32 s86, s86, 1
    s_cmp_gt_u32 s86, 65536
    s_cbranch_scc1 L_ok_28
    s_cbranch_vccnz L_rt_29
L_ok_28:
    v_cmp_ne_u32 vcc, s92, v211
    s_nop 0
    s_cmp_lg_u64 vcc, 0
    s_cselect_b32 s91, 1, 0
    s_mov_b32 s76, 3145728
    s_cmp_lg_u32 s91, 0
    s_cselect_b32 s76, 4096, s76
    s_add_u32 s80, s80, s76
    s_add_u32 s81, s81, s76
    s_cmp_lg_u32 s91, 0
    s_cselect_b32 s82, 0x7f000000, s82
    s_cselect_b32 s90, s90, 0x7f000000
    s_cmp_lg_u32 s91, 0
    s_cbranch_scc1 L_rm_30
    s_add_u32 s76, s80, 0
    buffer_load_dwordx4 v[128:131], v15, s[48:51], s76 offen nt
    s_add_u32 s76, s80, 5120
    buffer_load_dwordx4 v[132:135], v15, s[48:51], s76 offen nt
    s_add_u32 s76, s80, 10240
    buffer_load_dwordx4 v[136:139], v15, s[48:51], s76 offen nt
    s_add_u32 s76, s80, 15360
    buffer_load_dwordx4 v[140:143], v15, s[48:51], s76 offen nt
    s_add_u32 s76, s81, 0
    buffer_load_dwordx4 v[144:147], v15, s[48:51], s76 offen nt
    s_add_u32 s76, s81, 5120
    buffer_load_dwordx4 v[148:151], v15, s[48:51], s76 offen nt
    s_add_u32 s76, s81, 10240
    buffer_load_dwordx4 v[152:155], v15, s[48:51], s76 offen nt
    s_add_u32 s76, s81, 15360
    buffer_load_dwordx4 v[156:159], v15, s[48:51], s76 offen nt
    s_branch L_jn_31
L_rm_30:
    s_add_u32 s76, s80, 0
    buffer_load_dwordx4 v[128:131], v15, s[48:51], s76 offen sc1
    s_add_u32 s76, s80, 5120
    buffer_load_dwordx4 v[132:135], v15, s[48:51], s76 offen sc1
    s_add_u32 s76, s80, 10240
    buffer_load_dwordx4 v[136:139], v15, s[48:51], s76 offen sc1
    s_add_u32 s76, s80, 15360
    buffer_load_dwordx4 v[140:143], v15, s[48:51], s76 offen sc1
    s_add_u32 s76, s81, 0
    buffer_load_dwordx4 v[144:147], v15, s[48:51], s76 offen sc1
    s_add_u32 s76, s81, 5120
    buffer_load_dwordx4 v[148:151], v15, s[48:51], s76 offen sc1
    s_add_u32 s76, s81, 10240
    buffer_load_dwordx4 v[152:155], v15, s[48:51], s76 offen sc1
    s_add_u32 s76, s81, 15360
    buffer_load_dwordx4 v[156:159], v15, s[48:51], s76 offen sc1
L_jn_31:
    buffer_load_dwordx4 v[80:83], v8, s[32:35], s65 offen offset:0 nt
    buffer_load_dwordx4 v[84:87], v8, s[32:35], s65 offen offset:128 nt
    buffer_load_dwordx4 v[88:91], v8, s[32:35], s65 offen offset:256 nt
    buffer_load_dwordx4 v[92:95], v8, s[32:35], s66 offen offset:0 nt
    buffer_load_dwordx4 v[96:99], v8, s[32:35], s66 offen offset:128 nt
    buffer_load_dwordx4 v[100:103], v8, s[32:35], s66 offen offset:256 nt
    s_waitcnt vmcnt(6)
    v_bitop3_b32 v27, v129, v131, s73 bitop3:0x7e
    v_bitop3_b32 v28, v133, v135, s73 bitop3:0x7e
    v_or_b32 v27, v27, v28
    v_bitop3_b32 v28, v137, v139, s73 bitop3:0x7e
    v_or_b32 v27, v27, v28
    v_bitop3_b32 v28, v141, v143, s73 bitop3:0x7e
    v_or_b32 v27, v27, v28
    v_bitop3_b32 v29, v145, v147, s73 bitop3:0x7e
    v_bitop3_b32 v28, v149, v151, s73 bitop3:0x7e
    v_or_b32 v29, v29, v28
    v_bitop3_b32 v28, v153, v155, s73 bitop3:0x7e
    v_or_b32 v29, v29, v28
    v_bitop3_b32 v28, v157, v159, s73 bitop3:0x7e
    v_or_b32 v29, v29, v28
    s_cmp_eq_u32 s3, 7
    s_cselect_b32 s77, 0, -1
    v_and_b32 v29, s77, v29
    v_or_b32 v27, v27, v29
    v_cmp_ne_u32 vcc, 0, v27
    s_nop 0
    s_cbranch_vccz L_ok_32
    s_mov_b32 s86, 0
L_rt_33:
    s_add_u32 s76, s80, 0
    buffer_load_dwordx4 v[128:131], v15, s[48:51], s76 offen sc1
    s_add_u32 s76, s80, 5120
    buffer_load_dwordx4 v[132:135], v15, s[48:51], s76 offen sc1
    s_add_u32 s76, s80, 10240
    buffer_load_dwordx4 v[136:139], v15, s[48:51], s76 offen sc1
    s_add_u32 s76, s80, 15360
    buffer_load_dwordx4 v[140:143], v15, s[48:51], s76 offen sc1
    s_add_u32 s76, s81, 0
    buffer_load_dwordx4 v[144:147], v15, s[48:51], s76 offen sc1
    s_add_u32 s76, s81, 5120
    buffer_load_dwordx4 v[148:151], v15, s[48:51], s76 offen sc1
    s_add_u32 s76, s81, 10240
    buffer_load_dwordx4 v[152:155], v15, s[48:51], s76 offen sc1
    s_add_u32 s76, s81, 15360
    buffer_load_dwordx4 v[156:159], v15, s[48:51], s76 offen sc1
    s_waitcnt vmcnt(0)
    v_bitop3_b32 v27, v129, v131, s73 bitop3:0x7e
    v_bitop3_b32 v28, v133, v135, s73 bitop3:0x7e
    v_or_b32 v27, v27, v28
    v_bitop3_b32 v28, v137, v139, s73 bitop3:0x7e
    v_or_b32 v27, v27, v28
    v_bitop3_b32 v28, v141, v143, s73 bitop3:0x7e
    v_or_b32 v27, v27, v28
    v_bitop3_b32 v29, v145, v147, s73 bitop3:0x7e
    v_bitop3_b32 v28, v149, v151, s73 bitop3:0x7e
    v_or_b32 v29, v29, v28
    v_bitop3_b32 v28, v153, v155, s73 bitop3:0x7e
    v_or_b32 v29, v29, v28
    v_bitop3_b32 v28, v157, v159, s73 bitop3:0x7e
    v_or_b32 v29, v29, v28
    s_cmp_eq_u32 s3, 7
    s_cselect_b32 s77, 0, -1
    v_and_b32 v29, s77, v29
    v_or_b32 v27, v27, v29
    v_cmp_ne_u32 vcc, 0, v27
    s_add_u32 s86, s86, 1
    s_cmp_gt_u32 s86, 65536
    s_cbranch_scc1 L_ok_32
    s_cbranch_vccnz L_rt_33
L_ok_32:
    v_add_f32 v128, v128, v132
    v_add_f32 v130, v130, v134
    v_add_f32 v136, v136, v140
    v_add_f32 v138, v138, v142
    v_add_f32 v128, v128, v136
    v_add_f32 v130, v130, v138
    v_add_f32 v144, v144, v148
    v_add_f32 v146, v146, v150
    v_add_f32 v152, v152, v156
    v_add_f32 v154, v154, v158
    v_add_f32 v144, v144, v152
    v_add_f32 v146, v146, v154
    v_permlane32_swap_b32 v128, v130
    s_nop 0
    v_permlane32_swap_b32 v144, v146
    v_add_f32 v128, v128, v130
    v_add_f32 v144, v144, v146
    v_cvt_pk_bf16_f32 v128, v128, v128
    s_lshl_b32 s76, s84, 7
    s_lshl_b32 s77, s84, 2
    v_add_u32 v129, s76, v25
    v_mov_b32 v130, s77
    v_mov_b32 v131, 1
    ds_write_b16 v129, v128
    ds_write_b32 v130, v131
    v_cvt_pk_bf16_f32 v144, v144, v144
    s_lshl_b32 s76, s85, 7
    s_lshl_b32 s77, s85, 2
    s_cmp_eq_u32 s3, 7
    s_cselect_b32 s76, 704, s76
    s_cselect_b32 s77, 1024, s77
    v_add_u32 v145, s76, v25
    v_mov_b32 v146, s77
    v_mov_b32 v147, 1
    ds_write_b16 v145, v144
    ds_write_b32 v146, v147
    s_waitcnt vmcnt(3)
    buffer_load_dwordx4 v[104:107], v8, s[32:35], s67 offen offset:0 nt
    s_waitcnt vmcnt(3)
    buffer_load_dwordx4 v[108:111], v8, s[32:35], s67 offen offset:128 nt
    s_waitcnt vmcnt(3)
    buffer_load_dwordx4 v[112:115], v8, s[32:35], s67 offen offset:256 nt
    s_waitcnt vmcnt(3)
    buffer_load_dwordx4 v[116:119], v8, s[32:35], s68 offen offset:0 nt
    s_waitcnt vmcnt(3)
    buffer_load_dwordx4 v[120:123], v8, s[32:35], s68 offen offset:128 nt
    s_waitcnt vmcnt(3)
    buffer_load_dwordx4 v[124:127], v8, s[32:35], s68 offen offset:256 nt
    s_mov_b32 s86, 0
L_lw_34:
    ds_read_b128 v[248:251], v26
    ds_read_b32 v252, v26 offset:16
    s_add_u32 s86, s86, 1
    s_waitcnt lgkmcnt(0)
    v_and_b32 v248, v248, v249
    v_and_b32 v250, v250, v251
    v_bitop3_b32 v248, v248, v250, v252 bitop3:0x80
    v_cmp_ne_u32 vcc, 1, v248
    s_cmp_gt_u32 s86, 1048576
    s_cbranch_scc1 L_le_35
    s_cbranch_vccnz L_lw_34
L_le_35:
    ds_read_b128 v[200:203], v13 offset:0
    ds_read_b128 v[204:207], v13 offset:128
    ds_read_b128 v[208:211], v13 offset:256
    s_waitcnt lgkmcnt(0)
    v_dot2_f32_bf16 v240, v32, v200, 0
    v_dot2_f32_bf16 v241, v44, v200, 0
    v_dot2_f32_bf16 v242, v56, v200, 0
    v_dot2_f32_bf16 v243, v68, v200, 0
    v_dot2_f32_bf16 v240, v33, v201, v240
    v_dot2_f32_bf16 v241, v45, v201, v241
    v_dot2_f32_bf16 v242, v57, v201, v242
    v_dot2_f32_bf16 v243, v69, v201, v243
    v_dot2_f32_bf16 v240, v34, v202, v240
    v_dot2_f32_bf16 v241, v46, v202, v241
    v_dot2_f32_bf16 v242, v58, v202, v242
    v_dot2_f32_bf16 v243, v70, v202, v243
    v_dot2_f32_bf16 v240, v35, v203, v240
    v_dot2_f32_bf16 v241, v47, v203, v241
    v_dot2_f32_bf16 v242, v59, v203, v242
    v_dot2_f32_bf16 v243, v71, v203, v243
    v_dot2_f32_bf16 v240, v36, v204, v240
    v_dot2_f32_bf16 v241, v48, v204, v241
    v_dot2_f32_bf16 v242, v60, v204, v242
    v_dot2_f32_bf16 v243, v72, v204, v243
    v_dot2_f32_bf16 v240, v37, v205, v240
    v_dot2_f32_bf16 v241, v49, v205, v241
    v_dot2_f32_bf16 v242, v61, v205, v242
    v_dot2_f32_bf16 v243, v73, v205, v243
    v_dot2_f32_bf16 v240, v38, v206, v240
    v_dot2_f32_bf16 v241, v50, v206, v241
    v_dot2_f32_bf16 v242, v62, v206, v242
    v_dot2_f32_bf16 v243, v74, v206, v243
    v_dot2_f32_bf16 v240, v39, v207, v240
    v_dot2_f32_bf16 v241, v51, v207, v241
    v_dot2_f32_bf16 v242, v63, v207, v242
    v_dot2_f32_bf16 v243, v75, v207, v243
    v_dot2_f32_bf16 v240, v40, v208, v240
    v_dot2_f32_bf16 v241, v52, v208, v241
    v_dot2_f32_bf16 v242, v64, v208, v242
    v_dot2_f32_bf16 v243, v76, v208, v243
    v_dot2_f32_bf16 v240, v41, v209, v240
    v_dot2_f32_bf16 v241, v53, v209, v241
    v_dot2_f32_bf16 v242, v65, v209, v242
    v_dot2_f32_bf16 v243, v77, v209, v243
    v_dot2_f32_bf16 v240, v42, v210, v240
    v_dot2_f32_bf16 v241, v54, v210, v241
    v_dot2_f32_bf16 v242, v66, v210, v242
    v_dot2_f32_bf16 v243, v78, v210, v243
    v_dot2_f32_bf16 v240, v43, v211, v240
    v_dot2_f32_bf16 v241, v55, v211, v241
    v_dot2_f32_bf16 v242, v67, v211, v242
    v_dot2_f32_bf16 v243, v79, v211, v243
    v_add_f32_dpp v240, v240, v240 quad_perm:[1,0,3,2] row_mask:0xf bank_mask:0xf
    v_add_f32_dpp v241, v241, v241 quad_perm:[1,0,3,2] row_mask:0xf bank_mask:0xf
    v_add_f32_dpp v242, v242, v242 quad_perm:[1,0,3,2] row_mask:0xf bank_mask:0xf
    v_add_f32_dpp v243, v243, v243 quad_perm:[1,0,3,2] row_mask:0xf bank_mask:0xf
    v_add_f32_dpp v240, v240, v240 quad_perm:[2,3,0,1] row_mask:0xf bank_mask:0xf
    v_add_f32_dpp v241, v241, v241 quad_perm:[2,3,0,1] row_mask:0xf bank_mask:0xf
    v_add_f32_dpp v242, v242, v242 quad_perm:[2,3,0,1] row_mask:0xf bank_mask:0xf
    v_add_f32_dpp v243, v243, v243 quad_perm:[2,3,0,1] row_mask:0xf bank_mask:0xf
    v_add_f32_dpp v240, v240, v240 row_half_mirror row_mask:0xf bank_mask:0xf
    v_add_f32_dpp v241, v241, v241 row_half_mirror row_mask:0xf bank_mask:0xf
    v_add_f32_dpp v242, v242, v242 row_half_mirror row_mask:0xf bank_mask:0xf
    v_add_f32_dpp v243, v243, v243 row_half_mirror row_mask:0xf bank_mask:0xf
    v_cvt_pk_bf16_f32 v240, v240, v240
    v_cvt_pk_bf16_f32 v241, v241, v241
    v_cvt_pk_bf16_f32 v242, v242, v242
    v_cvt_pk_bf16_f32 v243, v243, v243
    v_and_b32 v240, 0xffff0000, v240
    v_and_b32 v241, 0xffff0000, v241
    v_and_b32 v242, 0xffff0000, v242
    v_and_b32 v243, 0xffff0000, v243
    v_mul_f32 v240, 0x3d93cd3a, v240
    v_mul_f32 v241, 0x3d93cd3a, v241
    v_mul_f32 v242, 0x3d93cd3a, v242
    v_mul_f32 v243, 0x3d93cd3a, v243
    v_cvt_pk_bf16_f32 v240, v240, v240
    v_cvt_pk_bf16_f32 v241, v241, v241
    v_cvt_pk_bf16_f32 v242, v242, v242
    v_cvt_pk_bf16_f32 v243, v243, v243
    v_and_b32 v240, 0xffff0000, v240
    v_and_b32 v241, 0xffff0000, v241
    v_and_b32 v242, 0xffff0000, v242
    v_and_b32 v243, 0xffff0000, v243
    v_max3_f32 v244, v240, v241, v242
    v_max_f32 v244, v244, v243
    s_nop 1
    v_max_f32_dpp v244, v244, v244 row_ror:8 row_mask:0xf bank_mask:0xf
    v_mov_b32 v245, v244
    s_nop 1
    v_permlane16_swap_b32 v245, v244
    v_max_f32 v244, v244, v245
    v_mov_b32 v245, v244
    s_nop 1
    v_permlane32_swap_b32 v245, v244
    v_max_f32 v244, v244, v245
    v_sub_f32 v240, v240, v244
    v_sub_f32 v241, v241, v244
    v_sub_f32 v242, v242, v244
    v_sub_f32 v243, v243, v244
    s_lshl_b32 s76, s3, 2
    s_add_u32 s76, s76, 32
    v_mov_b32 v245, s76
    v_mul_f32 v240, 0x3fb8aa3b, v240
    v_mul_f32 v241, 0x3fb8aa3b, v241
    v_mul_f32 v242, 0x3fb8aa3b, v242
    v_mul_f32 v243, 0x3fb8aa3b, v243
    ds_write_b32 v245, v244
    v_exp_f32 v240, v240
    v_exp_f32 v241, v241
    v_exp_f32 v242, v242
    v_exp_f32 v243, v243
    v_add_f32 v246, v240, v241
    v_add_f32 v247, v242, v243
    v_add_f32 v246, v246, v247
    v_cvt_pk_bf16_f32 v240, v240, v240
    v_cvt_pk_bf16_f32 v241, v241, v241
    v_cvt_pk_bf16_f32 v242, v242, v242
    v_cvt_pk_bf16_f32 v243, v243, v243
    v_add_f32_dpp v246, v246, v246 row_ror:8 row_mask:0xf bank_mask:0xf
    v_and_b32 v224, v240, v4
    v_and_b32 v225, v240, v5
    v_and_b32 v226, v240, v6
    v_and_b32 v227, v240, v7
    v_and_b32 v228, v241, v4
    v_and_b32 v229, v241, v5
    v_and_b32 v230, v241, v6
    v_and_b32 v231, v241, v7
    v_and_b32 v232, v242, v4
    v_and_b32 v233, v242, v5
    v_and_b32 v234, v242, v6
    v_and_b32 v235, v242, v7
    v_and_b32 v236, v243, v4
    v_and_b32 v237, v243, v5
    v_and_b32 v238, v243, v6
    v_and_b32 v239, v243, v7
    v_mov_b32 v247, v246
    s_nop 1
    v_permlane16_swap_b32 v247, v246
    v_add_f32 v246, v246, v247
    v_mov_b32 v247, v246
    s_nop 1
    v_permlane32_swap_b32 v247, v246
    v_add_f32 v246, v246, v247
    v_cmp_gt_u32 vcc, 32, v0
    v_mov_b32 v248, 0
    s_nop 0
    v_cndmask_b32 v249, 0, v246, vcc
    ds_write_b64 v23, v[248:249]
    v_mfma_f32_16x16x32_bf16 v[212:215], v[224:227], v[80:83], 0
    v_mfma_f32_16x16x32_bf16 v[216:219], v[224:227], v[84:87], 0
    v_mfma_f32_16x16x32_bf16 v[220:223], v[224:227], v[88:91], 0
    v_mfma_f32_16x16x32_bf16 v[212:215], v[228:231], v[92:95], v[212:215]
    v_mfma_f32_16x16x32_bf16 v[216:219], v[228:231], v[96:99], v[216:219]
    v_mfma_f32_16x16x32_bf16 v[220:223], v[228:231], v[100:103], v[220:223]
    v_mfma_f32_16x16x32_bf16 v[212:215], v[232:235], v[104:107], v[212:215]
    v_mfma_f32_16x16x32_bf16 v[216:219], v[232:235], v[108:111], v[216:219]
    s_waitcnt vmcnt(3)
    v_mfma_f32_16x16x32_bf16 v[220:223], v[232:235], v[112:115], v[220:223]
    s_waitcnt vmcnt(2)
    v_mfma_f32_16x16x32_bf16 v[212:215], v[236:239], v[116:119], v[212:215]
    s_waitcnt vmcnt(1)
    v_mfma_f32_16x16x32_bf16 v[216:219], v[236:239], v[120:123], v[216:219]
    s_waitcnt vmcnt(0)
    v_mfma_f32_16x16x32_bf16 v[220:223], v[236:239], v[124:127], v[220:223]
    s_mov_b32 exec_lo, 0x00ff00ff
    s_mov_b32 exec_hi, 0xff00ff00
    s_nop 1
    ds_write_b32 v19, v212 offset:0
    ds_write_b32 v19, v213 offset:48
    ds_write_b32 v19, v214 offset:96
    ds_write_b32 v19, v215 offset:144
    ds_write_b32 v20, v216 offset:0
    ds_write_b32 v20, v217 offset:48
    ds_write_b32 v20, v218 offset:96
    ds_write_b32 v20, v219 offset:144
    ds_write_b32 v21, v220 offset:0
    ds_write_b32 v21, v221 offset:48
    ds_write_b32 v21, v222 offset:96
    ds_write_b32 v21, v223 offset:144
    s_mov_b64 exec, -1
    s_waitcnt lgkmcnt(0)
    s_barrier
    ds_read_b32 v248, v255
    ds_read_b128 v[240:243], v22
    ds_read_b128 v[244:247], v22 offset:1680
    s_waitcnt lgkmcnt(2)
    v_max_f32_dpp v249, v248, v248 quad_perm:[1,0,3,2] row_mask:0xf bank_mask:0xf
    s_nop 1
    v_max_f32_dpp v249, v249, v249 quad_perm:[2,3,0,1] row_mask:0xf bank_mask:0xf
    s_nop 1
    v_max_f32_dpp v249, v249, v249 row_half_mirror row_mask:0xf bank_mask:0xf
    v_sub_f32 v248, v248, v249
    v_mul_f32 v248, 0x3fb8aa3b, v248
    v_exp_f32 v248, v248
    s_waitcnt lgkmcnt(0)
    v_add_f32 v240, v240, v244
    v_add_f32 v241, v241, v245
    v_add_f32 v242, v242, v246
    v_add_f32 v243, v243, v247
    v_mul_f32 v240, v240, v248
    v_mul_f32 v241, v241, v248
    v_mul_f32 v242, v242, v248
    v_mul_f32 v243, v243, v248
    v_add_f32_dpp v240, v240, v240 quad_perm:[1,0,3,2] row_mask:0xf bank_mask:0xf
    v_add_f32_dpp v241, v241, v241 quad_perm:[1,0,3,2] row_mask:0xf bank_mask:0xf
    v_add_f32_dpp v242, v242, v242 quad_perm:[1,0,3,2] row_mask:0xf bank_mask:0xf
    v_add_f32_dpp v243, v243, v243 quad_perm:[1,0,3,2] row_mask:0xf bank_mask:0xf
    v_add_f32_dpp v240, v240, v240 quad_perm:[2,3,0,1] row_mask:0xf bank_mask:0xf
    v_add_f32_dpp v241, v241, v241 quad_perm:[2,3,0,1] row_mask:0xf bank_mask:0xf
    v_add_f32_dpp v242, v242, v242 quad_perm:[2,3,0,1] row_mask:0xf bank_mask:0xf
    v_add_f32_dpp v243, v243, v243 quad_perm:[2,3,0,1] row_mask:0xf bank_mask:0xf
    v_add_f32_dpp v240, v240, v240 row_half_mirror row_mask:0xf bank_mask:0xf
    v_add_f32_dpp v241, v241, v241 row_half_mirror row_mask:0xf bank_mask:0xf
    v_add_f32_dpp v242, v242, v242 row_half_mirror row_mask:0xf bank_mask:0xf
    v_add_f32_dpp v243, v243, v243 row_half_mirror row_mask:0xf bank_mask:0xf
    v_cndmask_b32 v242, v242, v249, s[88:89]
    v_bfi_b32 v240, v11, s74, v240
    v_bfi_b32 v241, v11, s74, v241
    v_bfi_b32 v242, v11, s75, v242
    v_bfi_b32 v243, v11, s75, v243
    buffer_store_dwordx4 v[240:243], v18, s[48:51], s82 offen
    buffer_store_dwordx4 v[240:243], v17, s[48:51], s90 offen sc1
    s_cmp_eq_u32 s3, 6
    s_cbranch_scc0 L_done
    s_and_b32 s76, s2, 7
    s_lshr_b32 s77, s2, 6
    s_lshl_b32 s77, s77, 3
    s_add_u32 s76, s76, s77
    s_cmp_lt_u32 s76, 20
    s_cbranch_scc0 L_done
    s_lshl_b32 s76, s76, 3
    s_bfe_u32 s77, s2, 0x30003
    s_add_u32 s87, s76, s77
    v_mul_u32_u24 v16, 2560, v0
    s_cmp_ge_u32 s87, 80
    s_cselect_b32 s76, 1, 0
    s_mul_i32 s77, s76, 80
    s_sub_u32 s77, s87, s77
    s_lshl_b32 s77, s77, 4
    s_mul_i32 s76, s76, 1280
    s_add_u32 s76, s76, s77
    s_add_u32 s88, s76, 921600
    s_add_u32 s89, s76, 1249280
    v_bfe_u32 v27, v0, 4, 1
    v_lshrrev_b32 v28, 5, v0
    v_lshl_add_u32 v29, v27, 1, v28
    s_lshl_b32 s76, s87, 2
    v_add_u32 v29, s76, v29
    v_lshlrev_b32 v14, 1, v29
    buffer_load_ushort v144, v14, s[52:55], 0 offen
    v_and_b32 v27, 15, v0
    v_cmp_eq_u32 vcc, 0, v27
    v_mov_b32 v28, 0x80000000
    s_nop 0
    v_cndmask_b32 v15, v28, v14, vcc
    s_mov_b32 s86, 0
L_lw_36:
    ds_read_b32 v27, v26 offset:24
    s_add_u32 s86, s86, 1
    s_waitcnt lgkmcnt(0)
    v_cmp_ne_u32 vcc, 1, v27
    s_cmp_gt_u32 s86, 1048576
    s_cbranch_scc1 L_le_37
    s_cbranch_vccnz L_lw_36
L_le_37:
    buffer_load_dwordx4 v[128:131], v16, s[48:51], s89 offen sc1
    s_add_u32 s76, s89, 163840
    buffer_load_dwordx4 v[132:135], v16, s[48:51], s76 offen sc1
    buffer_load_dwordx4 v[136:139], v16, s[48:51], s88 offen sc1
    s_add_u32 s76, s88, 163840
    buffer_load_dwordx4 v[140:143], v16, s[48:51], s76 offen sc1
    s_add_u32 s77, s89, 163840
    s_waitcnt vmcnt(2)
    v_bitop3_b32 v27, v128, v129, s74 bitop3:0x7e
    v_bitop3_b32 v28, v132, v133, s74 bitop3:0x7e
    v_bitop3_b32 v29, v130, v131, s75 bitop3:0x7e
    v_bitop3_b32 v30, v134, v135, s75 bitop3:0x7e
    v_or3_b32 v27, v27, v28, v29
    v_bitop3_b32 v27, v27, v30, v11 bitop3:0xa8
    v_cmp_ne_u32 vcc, 0, v27
    s_nop 0
    s_cbranch_vccz L_okb_38
    s_mov_b32 s86, 0
L_mp_39:
    s_waitcnt vmcnt(0)
    v_bitop3_b32 v27, v128, v129, s74 bitop3:0x7e
    v_bitop3_b32 v28, v130, v131, s75 bitop3:0x7e
    v_bitop3_b32 v27, v27, v28, v11 bitop3:0xa8
    v_cmp_ne_u32 s[90:91], 0, v27
    v_bitop3_b32 v27, v132, v133, s74 bitop3:0x7e
    v_bitop3_b32 v28, v134, v135, s75 bitop3:0x7e
    v_bitop3_b32 v27, v27, v28, v11 bitop3:0xa8
    v_cmp_ne_u32 s[92:93], 0, v27
    s_nop 0
    s_or_b64 s[78:79], s[90:91], s[92:93]
    s_cbranch_scc0 L_md_40
    s_add_u32 s86, s86, 1
    s_cmp_gt_u32 s86, 65536
    s_cbranch_scc1 L_md_40
    s_mov_b64 exec, s[90:91]
    s_cbranch_execz L_k0_41
    buffer_load_dwordx4 v[128:131], v16, s[48:51], s89 offen sc1
L_k0_41:
    s_mov_b64 exec, s[92:93]
    s_cbranch_execz L_k1_42
    buffer_load_dwordx4 v[132:135], v16, s[48:51], s77 offen sc1
L_k1_42:
    s_mov_b64 exec, -1
    s_branch L_mp_39
L_md_40:
L_okb_38:
    v_bfi_b32 v128, v11, v12, v128
    v_bfi_b32 v129, v11, v12, v129
    v_bfi_b32 v130, v11, v12, v130
    v_bfi_b32 v131, v11, v12, v131
    v_bfi_b32 v132, v11, v12, v132
    v_bfi_b32 v133, v11, v12, v133
    v_bfi_b32 v134, v11, v12, v134
    v_bfi_b32 v135, v11, v12, v135
    v_add_f32 v128, v128, v132
    v_add_f32 v129, v129, v133
    v_add_f32 v130, v130, v134
    v_add_f32 v131, v131, v135
    v_permlane32_swap_b32 v128, v129
    s_nop 0
    v_permlane32_swap_b32 v130, v131
    v_add_f32 v128, v128, v129
    v_add_f32 v130, v130, v131
    s_nop 1
    v_permlane16_swap_b32 v128, v130
    v_add_f32 v145, v128, v130
    s_nop 1
    v_add_f32_dpp v145, v145, v145 row_ror:8 row_mask:0xf bank_mask:0xf
    s_nop 1
    v_add_f32_dpp v145, v145, v145 row_ror:4 row_mask:0xf bank_mask:0xf
    s_nop 1
    v_add_f32_dpp v145, v145, v145 row_ror:2 row_mask:0xf bank_mask:0xf
    s_nop 1
    v_add_f32_dpp v145, v145, v145 row_ror:1 row_mask:0xf bank_mask:0xf
    v_cvt_pk_bf16_f32 v145, v145, v145
    v_and_b32 v145, 0xffff0000, v145
    v_mul_f32 v27, 0xbfb8aa3b, v145
    v_exp_f32 v27, v27
    s_nop 0
    v_add_f32 v27, 1.0, v27
    v_rcp_f32 v28, v27
    s_nop 0
    v_mul_f32 v29, v145, v28
    v_fma_f32 v30, -v29, v27, v145
    v_fma_f32 v30, v30, v28, v29
    v_cmp_o_f32 vcc, v30, v30
    s_nop 1
    v_cndmask_b32 v145, v29, v30, vcc
    v_cvt_pk_bf16_f32 v145, v145, v145
    v_and_b32 v145, 0xffff0000, v145
    v_lshlrev_b32 v144, 16, v144
    s_add_u32 s77, s88, 163840
    s_mov_b32 s86, 0
L_mp_43:
    s_waitcnt vmcnt(0)
    v_bitop3_b32 v27, v136, v137, s74 bitop3:0x7e
    v_bitop3_b32 v28, v138, v139, s75 bitop3:0x7e
    v_bitop3_b32 v27, v27, v28, v11 bitop3:0xa8
    v_cmp_ne_u32 s[90:91], 0, v27
    v_bitop3_b32 v27, v140, v141, s74 bitop3:0x7e
    v_bitop3_b32 v28, v142, v143, s75 bitop3:0x7e
    v_bitop3_b32 v27, v27, v28, v11 bitop3:0xa8
    v_cmp_ne_u32 s[92:93], 0, v27
    s_nop 0
    s_or_b64 s[78:79], s[90:91], s[92:93]
    s_cbranch_scc0 L_md_44
    s_add_u32 s86, s86, 1
    s_cmp_gt_u32 s86, 65536
    s_cbranch_scc1 L_md_44
    s_mov_b64 exec, s[90:91]
    s_cbranch_execz L_k0_45
    buffer_load_dwordx4 v[136:139], v16, s[48:51], s88 offen sc1
L_k0_45:
    s_mov_b64 exec, s[92:93]
    s_cbranch_execz L_k1_46
    buffer_load_dwordx4 v[140:143], v16, s[48:51], s77 offen sc1
L_k1_46:
    s_mov_b64 exec, -1
    s_branch L_mp_43
L_md_44:
    v_bfi_b32 v160, v11, v12, v136
    v_bfi_b32 v161, v11, v12, v137
    v_bfi_b32 v162, v11, v12, v138
    v_bfi_b32 v163, v11, v12, v139
    v_bfi_b32 v164, v11, v12, v140
    v_bfi_b32 v165, v11, v12, v141
    v_bfi_b32 v166, v11, v12, v142
    v_bfi_b32 v167, v11, v12, v143
    v_add_f32 v160, v160, v164
    v_add_f32 v161, v161, v165
    v_add_f32 v162, v162, v166
    v_add_f32 v163, v163, v167
    v_permlane32_swap_b32 v160, v161
    s_nop 0
    v_permlane32_swap_b32 v162, v163
    v_add_f32 v160, v160, v161
    v_add_f32 v162, v162, v163
    s_nop 1
    v_permlane16_swap_b32 v160, v162
    v_add_f32 v146, v160, v162
    s_nop 1
    v_add_f32_dpp v146, v146, v146 row_ror:8 row_mask:0xf bank_mask:0xf
    s_nop 1
    v_add_f32_dpp v146, v146, v146 row_ror:4 row_mask:0xf bank_mask:0xf
    s_nop 1
    v_add_f32_dpp v146, v146, v146 row_ror:2 row_mask:0xf bank_mask:0xf
    s_nop 1
    v_add_f32_dpp v146, v146, v146 row_ror:1 row_mask:0xf bank_mask:0xf
    v_cvt_pk_bf16_f32 v146, v146, v146
    v_and_b32 v146, 0xffff0000, v146
    v_mul_f32 v146, v146, v145
    v_cvt_pk_bf16_f32 v146, v146, v146
    v_and_b32 v146, 0xffff0000, v146
    v_add_f32 v146, v144, v146
    v_cvt_pk_bf16_f32 v146, v146, v146
    buffer_store_short v146, v15, s[56:59], 0 offen
    s_cmp_lg_u32 s87, 0
    s_cbranch_scc1 L_done2
    v_mov_b32 v27, s73
    v_mov_b32 v28, 0x80000000
    v_cmp_eq_u32 vcc, 0, v0
    s_nop 1
    v_cndmask_b32 v28, v28, 0, vcc
    buffer_store_dword v27, v28, s[48:51], 0 offen sc1
L_done2:
L_done:
    s_endpgm
L_end:
    s_endpgm
L_code_end:
.section .rodata,"a"
.p2align 6
.amdhsa_kernel recurrent_scan__sliding_block_cached__glu_gated_reglu__decode_kernel
  .amdhsa_next_free_vgpr 256
  .amdhsa_next_free_sgpr 102
  .amdhsa_accum_offset 256
  .amdhsa_group_segment_fixed_size 0
  .amdhsa_kernarg_size 96
  .amdhsa_user_sgpr_count 2
  .amdhsa_user_sgpr_kernarg_segment_ptr 1
  .amdhsa_system_sgpr_workgroup_id_x 1
  .amdhsa_float_denorm_mode_32 3
.end_amdhsa_kernel
```
